```python
import torch

def _softmax(x, axis=-1):
    return torch.softmax(x, dim=axis)
def _gelu(x):
    return torch.nn.functional.gelu(x, approximate="tanh")
def _silu(x):
    return torch.nn.functional.silu(x)
def _sigmoid(x):
    return torch.sigmoid(x)
def _layernorm(x, axis=-1, eps=1e-5):
    m = x.mean(dim=axis, keepdim=True)
    v = x.var(dim=axis, keepdim=True, unbiased=False)
    return (x - m) / torch.sqrt(v + eps)
def _scatter_add(tgt, idx, src, axis=0):
    return tgt.clone().index_add_(axis, idx, src)
def _segment_sum(src, seg, n):
    out = torch.zeros((n,) + src.shape[1:], dtype=src.dtype)
    return out.index_add_(0, seg, src)
def _pad(x, pw):
    flat = tuple(v for pair in reversed(pw) for v in pair)
    return torch.nn.functional.pad(x, flat)

kernel_name = 'sequential_preLN__sliding_block__geglu_ffn__prompt'

def setup_inputs():

    _w = (lambda a: (lambda t: t.to(torch.bfloat16) if t.is_floating_point() else t)(torch.as_tensor(a)))
    def _A_setup():
        B, S, D = 1, 2048, 512
        return {
            "x": _w((lambda *s: torch.randn(*s, dtype=torch.bfloat16) * 0.05)(B, S, D)),
            "wqkv": _w((lambda *s: torch.randn(*s, dtype=torch.bfloat16) * 0.05)(D, 3 * D)),
            "wo": _w((lambda *s: torch.randn(*s, dtype=torch.bfloat16) * 0.05)(D, D)),
        }
    _A_in = _A_setup()

    def _B_setup():
        B, S, D, F = 1, 2048, 512, 1376
        return {
            "x": _w((lambda *s: torch.randn(*s, dtype=torch.bfloat16) * 0.05)(B, S, D)),
            "w_gate": _w((lambda *s: torch.randn(*s, dtype=torch.bfloat16) * 0.05)(D, F)),
            "w_up": _w((lambda *s: torch.randn(*s, dtype=torch.bfloat16) * 0.05)(D, F)),
            "w_down": _w((lambda *s: torch.randn(*s, dtype=torch.bfloat16) * 0.05)(F, D)),
        }
    _B_in = _B_setup()

    return {
        "A_x": _A_in["x"],
        "A_wqkv": _A_in["wqkv"],
        "A_wo": _A_in["wo"],
        "B_x": _B_in["x"],
        "B_w_gate": _B_in["w_gate"],
        "B_w_up": _B_in["w_up"],
        "B_w_down": _B_in["w_down"],
    }

def reference(A_x, A_wqkv, A_wo, B_x, B_w_gate, B_w_up, B_w_down):
    def _A_ref(x, wqkv, wo):
        B, S, D = x.shape
        H = 32; Dh = D // H; W = 256
        qkv = (lambda x, *d: x.permute(*d))((x @ wqkv).reshape(B, S, 3, H, Dh), 2, 0, 3, 1, 4)
        q, k, v = qkv[0], qkv[1], qkv[2]
        scores = torch.einsum("bhqd,bhkd->bhqk", q, k) * (Dh ** -0.5)
        idx = torch.arange(S)
        mask = (idx[:, None] - idx[None, :] >= 0) & (idx[:, None] - idx[None, :] < W)
        scores = torch.where(mask[None, None], scores, -1e9)
        p = _softmax(scores, axis=-1)
        o = torch.einsum("bhqk,bhkd->bhqd", p, v)
        return (lambda x, *d: x.permute(*d))(o, 0, 2, 1, 3).reshape(B, S, D) @ wo

    def _B_ref(x, w_gate, w_up, w_down):
        return (_gelu(x @ w_gate) * (x @ w_up)) @ w_down

    x = A_x
    h = x + _A_ref(_layernorm(x, axis=-1), A_wqkv, A_wo)
    h2 = h + _B_ref(_layernorm(h, axis=-1), B_w_gate, B_w_up, B_w_down)
    return h2
```

```asm
; @launch grid=(256,1,1) block=(768,1,1) lds=163840
.amdgcn_target "amdgcn-amd-amdhsa--gfx950"
.text
.globl sequential_preLN__sliding_block__geglu_ffn__prompt_kernel
.p2align 8
.type sequential_preLN__sliding_block__geglu_ffn__prompt_kernel,@function
sequential_preLN__sliding_block__geglu_ffn__prompt_kernel:

    s_cmp_ge_u32 s2, 256
    s_cbranch_scc1 sequential_preLN__sliding_block__geglu_ffn__prompt_kernel_done
    s_load_dwordx16 s[4:19], s[0:1], 0
    s_load_dwordx4 s[20:23], s[0:1], 64
    v_lshrrev_b32 v1, 6, v0
    v_and_b32 v0, 63, v0
    v_readfirstlane_b32 s3, v1
    s_and_b32 s24, s2, 7
    s_lshr_b32 s25, s2, 3
    s_and_b32 s99, s24, 6
    s_and_b32 s40, s25, 1
    s_add_u32 s99, s99, s40
    s_and_b32 s98, s24, 1
    s_lshl_b32 s98, s98, 4
    s_lshr_b32 s40, s25, 1
    s_add_u32 s98, s98, s40
    s_cmp_ge_u32 s98, 16
    s_cselect_b32 s40, 1, 0
    s_cmp_lt_u32 s98, 12
    s_cselect_b32 s100, 1, s40
    s_cmp_ge_u32 s3, 8
    s_cbranch_scc0 sequential_preLN__sliding_block__geglu_ffn__prompt_kernel_compute
    s_sub_u32 s46, s3, 8
    v_lshrrev_b32 v10, 3, v0
    v_and_b32 v11, 7, v0
    v_lshrrev_b32 v12, 4, v0
    s_and_b32 s47, s46, 1
    s_lshl_b32 s47, s47, 2
    v_xor_b32 v13, v11, v12
    v_xor_b32 v13, s47, v13
    v_lshlrev_b32 v13, 4, v13
    v_lshl_add_u32 v2, v10, 10, v13
    v_and_b32 v12, 1, v12
    v_lshlrev_b32 v12, 2, v12
    v_xor_b32 v13, v11, v12
    v_lshlrev_b32 v13, 4, v13
    v_mul_u32_u24 v3, 3072, v10
    v_add_u32_e64 v3, v3, v13
    v_lshl_add_u32 v4, v10, 10, v13
    s_lshl_b32 s48, s98, 16
    s_lshl_b32 s47, s46, 13
    s_add_u32 s48, s48, s47
    s_mul_i32 s49, s46, 24576
    s_lshl_b32 s47, s99, 7
    s_add_u32 s49, s49, s47
    s_lshl_b32 s50, s46, 10
    s_and_b32 s47, s99, 1
    s_lshl_b32 s47, s47, 2
    s_add_u32 s101, s98, s47
    s_waitcnt lgkmcnt(0)
    s_mov_b32 s28, s4
    s_mov_b32 s29, s5
    s_mov_b32 s30, 0x200000
    s_mov_b32 s31, 0x20000
    s_mov_b32 s32, s6
    s_mov_b32 s33, s7
    s_mov_b32 s34, 0x180000
    s_mov_b32 s35, 0x20000
    s_add_u32 s51, s101, 0
    s_and_b32 s51, s51, 7
    s_lshl_b32 s52, s51, 7
    s_add_u32 s52, s52, s48
    s_mul_i32 s53, s51, 196608
    s_add_u32 s53, s53, s49
    s_add_u32 m0, s50, 0
    s_nop 0
    buffer_load_dwordx4 v2, s[28:31], s52 offen lds
    s_add_u32 m0, s50, 4096
    s_add_u32 s63, s52, 32768
    buffer_load_dwordx4 v2, s[28:31], s63 offen lds
    s_add_u32 m0, s50, 8192
    s_nop 0
    buffer_load_dwordx4 v3, s[32:35], s53 offen lds
    s_add_u32 m0, s50, 12288
    s_add_u32 s63, s53, 98304
    buffer_load_dwordx4 v3, s[32:35], s63 offen lds
    s_add_u32 m0, s50, 16384
    s_add_u32 s63, s53, 1024
    buffer_load_dwordx4 v3, s[32:35], s63 offen lds
    s_add_u32 m0, s50, 20480
    s_add_u32 s63, s53, 99328
    buffer_load_dwordx4 v3, s[32:35], s63 offen lds
    s_add_u32 m0, s50, 24576
    s_add_u32 s63, s53, 2048
    buffer_load_dwordx4 v3, s[32:35], s63 offen lds
    s_add_u32 m0, s50, 28672
    s_add_u32 s63, s53, 100352
    buffer_load_dwordx4 v3, s[32:35], s63 offen lds
    s_add_u32 s51, s101, 1
    s_and_b32 s51, s51, 7
    s_lshl_b32 s52, s51, 7
    s_add_u32 s52, s52, s48
    s_mul_i32 s53, s51, 196608
    s_add_u32 s53, s53, s49
    s_add_u32 m0, s50, 32768
    s_nop 0
    buffer_load_dwordx4 v2, s[28:31], s52 offen lds
    s_add_u32 m0, s50, 36864
    s_add_u32 s63, s52, 32768
    buffer_load_dwordx4 v2, s[28:31], s63 offen lds
    s_add_u32 m0, s50, 40960
    s_nop 0
    buffer_load_dwordx4 v3, s[32:35], s53 offen lds
    s_add_u32 m0, s50, 45056
    s_add_u32 s63, s53, 98304
    buffer_load_dwordx4 v3, s[32:35], s63 offen lds
    s_add_u32 m0, s50, 49152
    s_add_u32 s63, s53, 1024
    buffer_load_dwordx4 v3, s[32:35], s63 offen lds
    s_add_u32 m0, s50, 53248
    s_add_u32 s63, s53, 99328
    buffer_load_dwordx4 v3, s[32:35], s63 offen lds
    s_add_u32 m0, s50, 57344
    s_add_u32 s63, s53, 2048
    buffer_load_dwordx4 v3, s[32:35], s63 offen lds
    s_add_u32 m0, s50, 61440
    s_add_u32 s63, s53, 100352
    buffer_load_dwordx4 v3, s[32:35], s63 offen lds
    s_add_u32 s51, s101, 2
    s_and_b32 s51, s51, 7
    s_lshl_b32 s52, s51, 7
    s_add_u32 s52, s52, s48
    s_mul_i32 s53, s51, 196608
    s_add_u32 s53, s53, s49
    s_add_u32 m0, s50, 65536
    s_nop 0
    buffer_load_dwordx4 v2, s[28:31], s52 offen lds
    s_add_u32 m0, s50, 69632
    s_add_u32 s63, s52, 32768
    buffer_load_dwordx4 v2, s[28:31], s63 offen lds
    s_add_u32 m0, s50, 73728
    s_nop 0
    buffer_load_dwordx4 v3, s[32:35], s53 offen lds
    s_add_u32 m0, s50, 77824
    s_add_u32 s63, s53, 98304
    buffer_load_dwordx4 v3, s[32:35], s63 offen lds
    s_add_u32 m0, s50, 81920
    s_add_u32 s63, s53, 1024
    buffer_load_dwordx4 v3, s[32:35], s63 offen lds
    s_add_u32 m0, s50, 86016
    s_add_u32 s63, s53, 99328
    buffer_load_dwordx4 v3, s[32:35], s63 offen lds
    s_add_u32 m0, s50, 90112
    s_add_u32 s63, s53, 2048
    buffer_load_dwordx4 v3, s[32:35], s63 offen lds
    s_add_u32 m0, s50, 94208
    s_add_u32 s63, s53, 100352
    buffer_load_dwordx4 v3, s[32:35], s63 offen lds
    s_waitcnt vmcnt(16)
    s_barrier
    s_add_u32 s51, s101, 3
    s_and_b32 s51, s51, 7
    s_lshl_b32 s52, s51, 7
    s_add_u32 s52, s52, s48
    s_mul_i32 s53, s51, 196608
    s_add_u32 s53, s53, s49
    s_add_u32 m0, s50, 98304
    s_nop 0
    buffer_load_dwordx4 v2, s[28:31], s52 offen lds
    s_add_u32 m0, s50, 102400
    s_add_u32 s63, s52, 32768
    buffer_load_dwordx4 v2, s[28:31], s63 offen lds
    s_add_u32 m0, s50, 106496
    s_nop 0
    buffer_load_dwordx4 v3, s[32:35], s53 offen lds
    s_add_u32 m0, s50, 110592
    s_add_u32 s63, s53, 98304
    buffer_load_dwordx4 v3, s[32:35], s63 offen lds
    s_add_u32 m0, s50, 114688
    s_add_u32 s63, s53, 1024
    buffer_load_dwordx4 v3, s[32:35], s63 offen lds
    s_add_u32 m0, s50, 118784
    s_add_u32 s63, s53, 99328
    buffer_load_dwordx4 v3, s[32:35], s63 offen lds
    s_add_u32 m0, s50, 122880
    s_add_u32 s63, s53, 2048
    buffer_load_dwordx4 v3, s[32:35], s63 offen lds
    s_add_u32 m0, s50, 126976
    s_add_u32 s63, s53, 100352
    buffer_load_dwordx4 v3, s[32:35], s63 offen lds
    s_waitcnt vmcnt(16)
    s_barrier
    s_add_u32 s51, s101, 4
    s_and_b32 s51, s51, 7
    s_lshl_b32 s52, s51, 7
    s_add_u32 s52, s52, s48
    s_mul_i32 s53, s51, 196608
    s_add_u32 s53, s53, s49
    s_add_u32 m0, s50, 0
    s_nop 0
    buffer_load_dwordx4 v2, s[28:31], s52 offen lds
    s_add_u32 m0, s50, 4096
    s_add_u32 s63, s52, 32768
    buffer_load_dwordx4 v2, s[28:31], s63 offen lds
    s_add_u32 m0, s50, 8192
    s_nop 0
    buffer_load_dwordx4 v3, s[32:35], s53 offen lds
    s_add_u32 m0, s50, 12288
    s_add_u32 s63, s53, 98304
    buffer_load_dwordx4 v3, s[32:35], s63 offen lds
    s_add_u32 m0, s50, 16384
    s_add_u32 s63, s53, 1024
    buffer_load_dwordx4 v3, s[32:35], s63 offen lds
    s_add_u32 m0, s50, 20480
    s_add_u32 s63, s53, 99328
    buffer_load_dwordx4 v3, s[32:35], s63 offen lds
    s_add_u32 m0, s50, 24576
    s_add_u32 s63, s53, 2048
    buffer_load_dwordx4 v3, s[32:35], s63 offen lds
    s_add_u32 m0, s50, 28672
    s_add_u32 s63, s53, 100352
    buffer_load_dwordx4 v3, s[32:35], s63 offen lds
    s_waitcnt vmcnt(16)
    s_barrier
    s_add_u32 s51, s101, 5
    s_and_b32 s51, s51, 7
    s_lshl_b32 s52, s51, 7
    s_add_u32 s52, s52, s48
    s_mul_i32 s53, s51, 196608
    s_add_u32 s53, s53, s49
    s_add_u32 m0, s50, 32768
    s_nop 0
    buffer_load_dwordx4 v2, s[28:31], s52 offen lds
    s_add_u32 m0, s50, 36864
    s_add_u32 s63, s52, 32768
    buffer_load_dwordx4 v2, s[28:31], s63 offen lds
    s_add_u32 m0, s50, 40960
    s_nop 0
    buffer_load_dwordx4 v3, s[32:35], s53 offen lds
    s_add_u32 m0, s50, 45056
    s_add_u32 s63, s53, 98304
    buffer_load_dwordx4 v3, s[32:35], s63 offen lds
    s_add_u32 m0, s50, 49152
    s_add_u32 s63, s53, 1024
    buffer_load_dwordx4 v3, s[32:35], s63 offen lds
    s_add_u32 m0, s50, 53248
    s_add_u32 s63, s53, 99328
    buffer_load_dwordx4 v3, s[32:35], s63 offen lds
    s_add_u32 m0, s50, 57344
    s_add_u32 s63, s53, 2048
    buffer_load_dwordx4 v3, s[32:35], s63 offen lds
    s_add_u32 m0, s50, 61440
    s_add_u32 s63, s53, 100352
    buffer_load_dwordx4 v3, s[32:35], s63 offen lds
    s_waitcnt vmcnt(16)
    s_barrier
    s_add_u32 s51, s101, 6
    s_and_b32 s51, s51, 7
    s_lshl_b32 s52, s51, 7
    s_add_u32 s52, s52, s48
    s_mul_i32 s53, s51, 196608
    s_add_u32 s53, s53, s49
    s_add_u32 m0, s50, 65536
    s_nop 0
    buffer_load_dwordx4 v2, s[28:31], s52 offen lds
    s_add_u32 m0, s50, 69632
    s_add_u32 s63, s52, 32768
    buffer_load_dwordx4 v2, s[28:31], s63 offen lds
    s_add_u32 m0, s50, 73728
    s_nop 0
    buffer_load_dwordx4 v3, s[32:35], s53 offen lds
    s_add_u32 m0, s50, 77824
    s_add_u32 s63, s53, 98304
    buffer_load_dwordx4 v3, s[32:35], s63 offen lds
    s_add_u32 m0, s50, 81920
    s_add_u32 s63, s53, 1024
    buffer_load_dwordx4 v3, s[32:35], s63 offen lds
    s_add_u32 m0, s50, 86016
    s_add_u32 s63, s53, 99328
    buffer_load_dwordx4 v3, s[32:35], s63 offen lds
    s_add_u32 m0, s50, 90112
    s_add_u32 s63, s53, 2048
    buffer_load_dwordx4 v3, s[32:35], s63 offen lds
    s_add_u32 m0, s50, 94208
    s_add_u32 s63, s53, 100352
    buffer_load_dwordx4 v3, s[32:35], s63 offen lds
    s_waitcnt vmcnt(16)
    s_barrier
    s_add_u32 s51, s101, 7
    s_and_b32 s51, s51, 7
    s_lshl_b32 s52, s51, 7
    s_add_u32 s52, s52, s48
    s_mul_i32 s53, s51, 196608
    s_add_u32 s53, s53, s49
    s_add_u32 m0, s50, 98304
    s_nop 0
    buffer_load_dwordx4 v2, s[28:31], s52 offen lds
    s_add_u32 m0, s50, 102400
    s_add_u32 s63, s52, 32768
    buffer_load_dwordx4 v2, s[28:31], s63 offen lds
    s_add_u32 m0, s50, 106496
    s_nop 0
    buffer_load_dwordx4 v3, s[32:35], s53 offen lds
    s_add_u32 m0, s50, 110592
    s_add_u32 s63, s53, 98304
    buffer_load_dwordx4 v3, s[32:35], s63 offen lds
    s_add_u32 m0, s50, 114688
    s_add_u32 s63, s53, 1024
    buffer_load_dwordx4 v3, s[32:35], s63 offen lds
    s_add_u32 m0, s50, 118784
    s_add_u32 s63, s53, 99328
    buffer_load_dwordx4 v3, s[32:35], s63 offen lds
    s_add_u32 m0, s50, 122880
    s_add_u32 s63, s53, 2048
    buffer_load_dwordx4 v3, s[32:35], s63 offen lds
    s_add_u32 m0, s50, 126976
    s_add_u32 s63, s53, 100352
    buffer_load_dwordx4 v3, s[32:35], s63 offen lds
    s_waitcnt vmcnt(16)
    s_barrier
    v_lshlrev_b32 v5, 4, v0
    v_lshrrev_b32 v10, 1, v0
    v_and_b32_e64 v11, 1, v0
    v_bfe_u32 v12, v0, 4, 1
    v_xor_b32 v12, v12, v11
    v_lshlrev_b32 v12, 4, v12
    v_lshl_add_u32 v6, v10, 5, v12
    v_bfe_u32 v12, v0, 5, 1
    v_lshlrev_b32 v12, 2, v12
    v_xor_b32 v12, v12, v10
    v_lshlrev_b32_e64 v11, 4, v11
    v_lshl_add_u32 v7, v12, 5, v11
    s_lshl_b32 s47, s46, 6
    s_mov_b32 s51, 0xAAAAAAAB
    v_add_u32 v8, s47, v0
    v_add_u32_e64 v8, 0, v8
    v_mul_hi_u32 v9, v8, s51
    v_lshrrev_b32 v9, 3, v9
    v_mul_u32_u24 v10, 12, v9
    v_sub_u32_e64 v10, v8, v10
    v_mul_u32_u24 v9, 2752, v9
    v_lshl_add_u32 v20, v10, 4, v9
    v_xor_b32_e64 v10, 2, v10
    v_lshl_add_u32 v23, v10, 4, v9
    v_add_u32_e64 v8, s47, v0
    v_add_u32 v8, 256, v8
    v_mul_hi_u32 v9, v8, s51
    v_lshrrev_b32 v9, 3, v9
    v_mul_u32_u24 v10, 12, v9
    v_sub_u32_e64 v10, v8, v10
    v_mul_u32_u24 v9, 2752, v9
    v_lshl_add_u32 v21, v10, 4, v9
    v_xor_b32_e64 v10, 2, v10
    v_lshl_add_u32 v24, v10, 4, v9
    v_add_u32_e64 v8, s47, v0
    v_add_u32 v8, 512, v8
    v_mul_hi_u32 v9, v8, s51
    v_lshrrev_b32 v9, 3, v9
    v_mul_u32_u24 v10, 12, v9
    v_sub_u32_e64 v10, v8, v10
    v_mul_u32_u24 v9, 2752, v9
    v_lshl_add_u32 v22, v10, 4, v9
    v_xor_b32_e64 v10, 2, v10
    v_lshl_add_u32 v25, v10, 4, v9
    s_lshl_b32 s56, s24, 2
    s_lshr_b32 s40, s25, 3
    s_add_u32 s56, s56, s40
    s_and_b32 s57, s25, 7
    s_lshl_b32 s58, s24, 1
    s_and_b32 s40, s25, 1
    s_add_u32 s58, s58, s40
    s_lshr_b32 s59, s25, 1
    s_mov_b32 s36, s22
    s_mov_b32 s37, s23
    s_mov_b32 s38, 0x20000
    s_mov_b32 s39, 0x20000
    s_waitcnt vmcnt(8)
    s_barrier
    s_waitcnt vmcnt(0)
    s_barrier
    s_barrier
    v_mov_b32 v10, 67584
    ds_read_b64 v[14:15], v10
    s_mov_b32 s32, s8
    s_mov_b32 s33, s9
    s_mov_b32 s34, 0x80000
    s_mov_b32 s35, 0x20000
    s_waitcnt lgkmcnt(0)
    v_readfirstlane_b32 s26, v14
    v_readfirstlane_b32 s27, v15
    s_nop 0
    s_and_b32 s100, s100, s27
    s_barrier
    s_lshl_b32 s47, s99, 5
    s_add_u32 s47, s47, s98
    s_cmp_eq_u32 s3, 8
    s_cbranch_scc0 fl_1
    s_lshr_b32 s43, s47, 0
    s_lshl_b32 s43, s43, 7
    s_and_b32 s42, s47, 0
    s_lshl_b32 s42, s42, 2
    s_add_u32 s43, s43, s42
    s_add_u32 s43, s43, 0
    v_mov_b32 v10, s26
    v_mov_b32 v11, 0
    s_mov_b64 s[40:41], exec
    s_mov_b64 exec, 1
    s_cmp_eq_u32 s100, 0
    s_cbranch_scc1 tw_2
    buffer_store_dword v10, v11, s[36:39], s43 offen
tw_2_e:
    s_mov_b64 exec, s[40:41]
fl_1:
    s_cmp_eq_u32 s3, 9
    s_cbranch_scc0 L_xc_skip
    s_getreg_b32 s43, hwreg(HW_REG_XCC_ID)
    s_and_b32 s43, s43, 7
    s_add_u32 s43, s43, s26
    v_mov_b32 v10, s43
    s_lshl_b32 s43, s24, 7
    s_lshl_b32 s42, s25, 2
    s_add_u32 s43, s43, s42
    s_add_u32 s43, s43, 262144
    v_mov_b32 v11, s43
    s_mov_b64 s[40:41], exec
    s_mov_b64 exec, 1
    global_store_dword v11, v10, s[22:23] sc1
    s_mov_b64 exec, s[40:41]
L_xc_skip:
    s_min_u32 s60, s98, 4
    s_sub_u32 s47, s47, 1
    v_sub_u32 v10, s47, v0
    v_lshlrev_b32 v10, 7, v10
    s_mov_b64 s[40:41], exec
    s_lshl_b64 s[44:45], 1, s60
    s_sub_u32 s44, s44, 1
    s_subb_u32 s45, s45, 0
    s_mov_b64 exec, s[44:45]
    s_cbranch_execz poll1_done
    s_mov_b32 s42, 0
poll1:
    buffer_load_dword v11, v10, s[36:39], 0 offen sc1
    s_waitcnt vmcnt(0)
    v_cmp_ne_u32 vcc, s26, v11
    s_cbranch_vccz poll1_done
    s_sleep 1
    s_add_u32 s42, s42, 1
    s_cmp_lt_u32 s42, 20000
    s_cbranch_scc1 poll1
poll1_done:
    s_mov_b64 exec, s[40:41]
    s_add_u32 s28, s22, 0x100000
    s_addc_u32 s29, s23, 0
    s_mov_b32 s30, 0x400000
    s_mov_b32 s31, 0x20000
    s_lshl_b32 s48, s99, 2
    s_add_u32 s48, s48, s46
    s_lshl_b32 s48, s48, 16
    s_lshl_b32 s49, s98, 1
    s_sub_u32 s49, s49, 8
    s_mul_i32 s51, s46, 10240
    s_add_i32 s62, s49, 0
    s_max_i32 s62, s62, 0
    s_lshl_b32 s62, s62, 10
    s_add_u32 s62, s62, s48
    s_add_u32 m0, s51, 0
    s_nop 0
    buffer_load_dwordx4 v6, s[28:31], s62 offen sc1 lds
    s_add_i32 s62, s49, 1
    s_max_i32 s62, s62, 0
    s_lshl_b32 s62, s62, 10
    s_add_u32 s62, s62, s48
    s_add_u32 m0, s51, 1024
    s_nop 0
    buffer_load_dwordx4 v6, s[28:31], s62 offen sc1 lds
    s_add_i32 s62, s49, 2
    s_max_i32 s62, s62, 0
    s_lshl_b32 s62, s62, 10
    s_add_u32 s62, s62, s48
    s_add_u32 m0, s51, 2048
    s_nop 0
    buffer_load_dwordx4 v6, s[28:31], s62 offen sc1 lds
    s_add_i32 s62, s49, 3
    s_max_i32 s62, s62, 0
    s_lshl_b32 s62, s62, 10
    s_add_u32 s62, s62, s48
    s_add_u32 m0, s51, 3072
    s_nop 0
    buffer_load_dwordx4 v6, s[28:31], s62 offen sc1 lds
    s_add_i32 s62, s49, 4
    s_max_i32 s62, s62, 0
    s_lshl_b32 s62, s62, 10
    s_add_u32 s62, s62, s48
    s_add_u32 m0, s51, 4096
    s_nop 0
    buffer_load_dwordx4 v6, s[28:31], s62 offen sc1 lds
    s_add_i32 s62, s49, 5
    s_max_i32 s62, s62, 0
    s_lshl_b32 s62, s62, 10
    s_add_u32 s62, s62, s48
    s_add_u32 m0, s51, 5120
    s_nop 0
    buffer_load_dwordx4 v6, s[28:31], s62 offen sc1 lds
    s_add_i32 s62, s49, 6
    s_max_i32 s62, s62, 0
    s_lshl_b32 s62, s62, 10
    s_add_u32 s62, s62, s48
    s_add_u32 m0, s51, 6144
    s_nop 0
    buffer_load_dwordx4 v6, s[28:31], s62 offen sc1 lds
    s_add_i32 s62, s49, 7
    s_max_i32 s62, s62, 0
    s_lshl_b32 s62, s62, 10
    s_add_u32 s62, s62, s48
    s_add_u32 m0, s51, 7168
    s_nop 0
    buffer_load_dwordx4 v6, s[28:31], s62 offen sc1 lds
    s_add_i32 s62, s49, 8
    s_max_i32 s62, s62, 0
    s_lshl_b32 s62, s62, 10
    s_add_u32 s62, s62, s48
    s_add_u32 m0, s51, 8192
    s_nop 0
    buffer_load_dwordx4 v6, s[28:31], s62 offen sc1 lds
    s_add_i32 s62, s49, 9
    s_max_i32 s62, s62, 0
    s_lshl_b32 s62, s62, 10
    s_add_u32 s62, s62, s48
    s_add_u32 m0, s51, 9216
    s_nop 0
    buffer_load_dwordx4 v6, s[28:31], s62 offen sc1 lds
    s_add_i32 s62, s49, 0
    s_max_i32 s62, s62, 0
    s_lshl_b32 s62, s62, 10
    s_add_u32 s62, s62, s48
    s_add_u32 m0, s51, 40960
    s_add_u32 s63, s62, 2097152
    buffer_load_dwordx4 v7, s[28:31], s63 offen sc1 lds
    s_add_i32 s62, s49, 1
    s_max_i32 s62, s62, 0
    s_lshl_b32 s62, s62, 10
    s_add_u32 s62, s62, s48
    s_add_u32 m0, s51, 41984
    s_add_u32 s63, s62, 2097152
    buffer_load_dwordx4 v7, s[28:31], s63 offen sc1 lds
    s_add_i32 s62, s49, 2
    s_max_i32 s62, s62, 0
    s_lshl_b32 s62, s62, 10
    s_add_u32 s62, s62, s48
    s_add_u32 m0, s51, 43008
    s_add_u32 s63, s62, 2097152
    buffer_load_dwordx4 v7, s[28:31], s63 offen sc1 lds
    s_add_i32 s62, s49, 3
    s_max_i32 s62, s62, 0
    s_lshl_b32 s62, s62, 10
    s_add_u32 s62, s62, s48
    s_add_u32 m0, s51, 44032
    s_add_u32 s63, s62, 2097152
    buffer_load_dwordx4 v7, s[28:31], s63 offen sc1 lds
    s_add_i32 s62, s49, 4
    s_max_i32 s62, s62, 0
    s_lshl_b32 s62, s62, 10
    s_add_u32 s62, s62, s48
    s_add_u32 m0, s51, 45056
    s_add_u32 s63, s62, 2097152
    buffer_load_dwordx4 v7, s[28:31], s63 offen sc1 lds
    s_add_i32 s62, s49, 5
    s_max_i32 s62, s62, 0
    s_lshl_b32 s62, s62, 10
    s_add_u32 s62, s62, s48
    s_add_u32 m0, s51, 46080
    s_add_u32 s63, s62, 2097152
    buffer_load_dwordx4 v7, s[28:31], s63 offen sc1 lds
    s_add_i32 s62, s49, 6
    s_max_i32 s62, s62, 0
    s_lshl_b32 s62, s62, 10
    s_add_u32 s62, s62, s48
    s_add_u32 m0, s51, 47104
    s_add_u32 s63, s62, 2097152
    buffer_load_dwordx4 v7, s[28:31], s63 offen sc1 lds
    s_add_i32 s62, s49, 7
    s_max_i32 s62, s62, 0
    s_lshl_b32 s62, s62, 10
    s_add_u32 s62, s62, s48
    s_add_u32 m0, s51, 48128
    s_add_u32 s63, s62, 2097152
    buffer_load_dwordx4 v7, s[28:31], s63 offen sc1 lds
    s_add_i32 s62, s49, 8
    s_max_i32 s62, s62, 0
    s_lshl_b32 s62, s62, 10
    s_add_u32 s62, s62, s48
    s_add_u32 m0, s51, 49152
    s_add_u32 s63, s62, 2097152
    buffer_load_dwordx4 v7, s[28:31], s63 offen sc1 lds
    s_add_i32 s62, s49, 9
    s_max_i32 s62, s62, 0
    s_lshl_b32 s62, s62, 10
    s_add_u32 s62, s62, s48
    s_add_u32 m0, s51, 50176
    s_add_u32 s63, s62, 2097152
    buffer_load_dwordx4 v7, s[28:31], s63 offen sc1 lds
    s_waitcnt vmcnt(10)
    s_barrier
    s_waitcnt vmcnt(0)
    s_barrier
    s_cmp_eq_u32 s3, 9
    s_cbranch_scc0 L_xq_skip
    s_lshl_b32 s43, s24, 7
    s_add_u32 s43, s43, 262144
    v_lshl_add_u32 v10, v0, 2, s43
    s_getreg_b32 s43, hwreg(HW_REG_XCC_ID)
    s_and_b32 s43, s43, 7
    s_mov_b64 s[40:41], exec
    s_mov_b32 exec_lo, -1
    s_mov_b32 exec_hi, 0
    s_mov_b32 s42, 0
L_xq_poll:
    global_load_dword v11, v10, s[22:23] sc1
    s_waitcnt vmcnt(0)
    v_subrev_u32 v11, s26, v11
    v_cmp_le_u32 vcc, 8, v11
    s_cbranch_vccz L_xq_ok
    s_sleep 1
    s_add_u32 s42, s42, 1
    s_cmp_lt_u32 s42, 20000
    s_cbranch_scc1 L_xq_poll
L_xq_ok:
    v_cmp_ne_u32 vcc, s43, v11
    s_nop 1
    s_cmp_eq_u64 vcc, 0
    s_cselect_b32 s43, 1, 0
    s_mov_b64 exec, s[40:41]
    v_mov_b32 v11, s43
    v_mov_b32 v10, 90112
    ds_write_b32 v10, v11
    s_waitcnt lgkmcnt(0)
L_xq_skip:
    s_and_b32 s61, s56, 3
    s_lshl_b32 s61, s61, 1
    s_add_u32 s61, s61, s57
    s_lshl_b32 s49, s46, 13
    s_lshl_b32 s47, s57, 7
    s_add_u32 s49, s49, s47
    s_add_u32 s51, s61, 0
    s_and_b32 s51, s51, 7
    s_lshl_b32 s51, s51, 16
    s_add_u32 s51, s51, s49
    s_add_u32 m0, s50, 98304
    s_nop 0
    buffer_load_dwordx4 v4, s[32:35], s51 offen lds
    s_add_u32 m0, s50, 102400
    s_add_u32 s63, s51, 32768
    buffer_load_dwordx4 v4, s[32:35], s63 offen lds
    s_add_u32 s51, s61, 1
    s_and_b32 s51, s51, 7
    s_lshl_b32 s51, s51, 16
    s_add_u32 s51, s51, s49
    s_add_u32 m0, s50, 106496
    s_nop 0
    buffer_load_dwordx4 v4, s[32:35], s51 offen lds
    s_add_u32 m0, s50, 110592
    s_add_u32 s63, s51, 32768
    buffer_load_dwordx4 v4, s[32:35], s63 offen lds
    s_add_u32 s51, s61, 2
    s_and_b32 s51, s51, 7
    s_lshl_b32 s51, s51, 16
    s_add_u32 s51, s51, s49
    s_add_u32 m0, s50, 114688
    s_nop 0
    buffer_load_dwordx4 v4, s[32:35], s51 offen lds
    s_add_u32 m0, s50, 118784
    s_add_u32 s63, s51, 32768
    buffer_load_dwordx4 v4, s[32:35], s63 offen lds
    s_add_u32 s51, s61, 3
    s_and_b32 s51, s51, 7
    s_lshl_b32 s51, s51, 16
    s_add_u32 s51, s51, s49
    s_add_u32 m0, s50, 122880
    s_nop 0
    buffer_load_dwordx4 v4, s[32:35], s51 offen lds
    s_add_u32 m0, s50, 126976
    s_add_u32 s63, s51, 32768
    buffer_load_dwordx4 v4, s[32:35], s63 offen lds
    s_add_u32 s51, s61, 4
    s_and_b32 s51, s51, 7
    s_lshl_b32 s51, s51, 16
    s_add_u32 s51, s51, s49
    s_add_u32 m0, s50, 131072
    s_nop 0
    buffer_load_dwordx4 v4, s[32:35], s51 offen lds
    s_add_u32 m0, s50, 135168
    s_add_u32 s63, s51, 32768
    buffer_load_dwordx4 v4, s[32:35], s63 offen lds
    s_add_u32 s51, s61, 5
    s_and_b32 s51, s51, 7
    s_lshl_b32 s51, s51, 16
    s_add_u32 s51, s51, s49
    s_add_u32 m0, s50, 139264
    s_nop 0
    buffer_load_dwordx4 v4, s[32:35], s51 offen lds
    s_add_u32 m0, s50, 143360
    s_add_u32 s63, s51, 32768
    buffer_load_dwordx4 v4, s[32:35], s63 offen lds
    s_add_u32 s51, s61, 6
    s_and_b32 s51, s51, 7
    s_lshl_b32 s51, s51, 16
    s_add_u32 s51, s51, s49
    s_add_u32 m0, s50, 147456
    s_nop 0
    buffer_load_dwordx4 v4, s[32:35], s51 offen lds
    s_add_u32 m0, s50, 151552
    s_add_u32 s63, s51, 32768
    buffer_load_dwordx4 v4, s[32:35], s63 offen lds
    s_add_u32 s51, s61, 7
    s_and_b32 s51, s51, 7
    s_lshl_b32 s51, s51, 16
    s_add_u32 s51, s51, s49
    s_add_u32 m0, s50, 155648
    s_nop 0
    buffer_load_dwordx4 v4, s[32:35], s51 offen lds
    s_add_u32 m0, s50, 159744
    s_add_u32 s63, s51, 32768
    buffer_load_dwordx4 v4, s[32:35], s63 offen lds
    s_lshl_b32 s47, s25, 2
    s_add_u32 s47, s47, s46
    s_lshl_b32 s47, s47, 14
    s_add_u32 s62, s47, 8192
    v_lshlrev_b32 v10, 7, v0
    s_mov_b32 s52, s12
    s_mov_b32 s53, s13
    s_mov_b32 s54, 0x158000
    s_mov_b32 s55, 0x20000
    buffer_load_dword v12, v10, s[52:55], s47 offen
    buffer_load_dword v13, v10, s[52:55], s62 offen
    s_barrier
    v_mov_b32 v10, 90112
    ds_read_b32 v11, v10
    s_waitcnt lgkmcnt(0)
    v_readfirstlane_b32 s27, v11
    s_barrier
    s_lshl_b32 s47, s98, 3
    s_add_u32 s47, s47, s99
    s_cmp_eq_u32 s3, 8
    s_cbranch_scc0 fl_3
    s_lshr_b32 s43, s47, 0
    s_lshl_b32 s43, s43, 7
    s_and_b32 s42, s47, 0
    s_lshl_b32 s42, s42, 2
    s_add_u32 s43, s43, s42
    s_add_u32 s43, s43, 32768
    v_mov_b32 v10, s26
    v_mov_b32 v11, 0
    s_mov_b64 s[40:41], exec
    s_mov_b64 exec, 1
    buffer_store_dword v10, v11, s[36:39], s43 offen sc1
    s_mov_b64 exec, s[40:41]
fl_3:
    s_lshl_b32 s47, s56, 10
    s_add_u32 s47, s47, 32768
    v_lshl_add_u32 v10, v0, 7, s47
    s_mov_b64 s[40:41], exec
    s_mov_b64 exec, 0xff
    s_mov_b32 s42, 0
poll2:
    buffer_load_dword v11, v10, s[36:39], 0 offen sc1
    s_waitcnt vmcnt(0)
    v_cmp_ne_u32 vcc, s26, v11
    s_cbranch_vccz poll2_done
    s_sleep 1
    s_add_u32 s42, s42, 1
    s_cmp_lt_u32 s42, 20000
    s_cbranch_scc1 poll2
poll2_done:
    s_mov_b64 exec, s[40:41]
    s_add_u32 s28, s22, 0x500000
    s_addc_u32 s29, s23, 0
    s_mov_b32 s30, 0x200000
    s_mov_b32 s31, 0x20000
    s_lshl_b32 s48, s56, 16
    s_lshl_b32 s47, s46, 11
    s_add_u32 s48, s48, s47
    s_lshl_b32 s51, s46, 11
    s_add_u32 s52, s61, 0
    s_and_b32 s52, s52, 7
    s_lshl_b32 s52, s52, 13
    s_add_u32 s52, s52, s48
    s_add_u32 m0, s51, 0
    s_nop 0
    buffer_load_dwordx4 v5, s[28:31], s52 offen sc1 lds
    s_add_u32 m0, s51, 1024
    s_add_u32 s63, s52, 1024
    buffer_load_dwordx4 v5, s[28:31], s63 offen sc1 lds
    s_add_u32 s52, s61, 1
    s_and_b32 s52, s52, 7
    s_lshl_b32 s52, s52, 13
    s_add_u32 s52, s52, s48
    s_add_u32 m0, s51, 8192
    s_nop 0
    buffer_load_dwordx4 v5, s[28:31], s52 offen sc1 lds
    s_add_u32 m0, s51, 9216
    s_add_u32 s63, s52, 1024
    buffer_load_dwordx4 v5, s[28:31], s63 offen sc1 lds
    s_add_u32 s52, s61, 2
    s_and_b32 s52, s52, 7
    s_lshl_b32 s52, s52, 13
    s_add_u32 s52, s52, s48
    s_add_u32 m0, s51, 16384
    s_nop 0
    buffer_load_dwordx4 v5, s[28:31], s52 offen sc1 lds
    s_add_u32 m0, s51, 17408
    s_add_u32 s63, s52, 1024
    buffer_load_dwordx4 v5, s[28:31], s63 offen sc1 lds
    s_add_u32 s52, s61, 3
    s_and_b32 s52, s52, 7
    s_lshl_b32 s52, s52, 13
    s_add_u32 s52, s52, s48
    s_add_u32 m0, s51, 24576
    s_nop 0
    buffer_load_dwordx4 v5, s[28:31], s52 offen sc1 lds
    s_add_u32 m0, s51, 25600
    s_add_u32 s63, s52, 1024
    buffer_load_dwordx4 v5, s[28:31], s63 offen sc1 lds
    s_add_u32 s52, s61, 4
    s_and_b32 s52, s52, 7
    s_lshl_b32 s52, s52, 13
    s_add_u32 s52, s52, s48
    s_add_u32 m0, s51, 32768
    s_nop 0
    buffer_load_dwordx4 v5, s[28:31], s52 offen sc1 lds
    s_add_u32 m0, s51, 33792
    s_add_u32 s63, s52, 1024
    buffer_load_dwordx4 v5, s[28:31], s63 offen sc1 lds
    s_add_u32 s52, s61, 5
    s_and_b32 s52, s52, 7
    s_lshl_b32 s52, s52, 13
    s_add_u32 s52, s52, s48
    s_add_u32 m0, s51, 40960
    s_nop 0
    buffer_load_dwordx4 v5, s[28:31], s52 offen sc1 lds
    s_add_u32 m0, s51, 41984
    s_add_u32 s63, s52, 1024
    buffer_load_dwordx4 v5, s[28:31], s63 offen sc1 lds
    s_add_u32 s52, s61, 6
    s_and_b32 s52, s52, 7
    s_lshl_b32 s52, s52, 13
    s_add_u32 s52, s52, s48
    s_add_u32 m0, s51, 49152
    s_nop 0
    buffer_load_dwordx4 v5, s[28:31], s52 offen sc1 lds
    s_add_u32 m0, s51, 50176
    s_add_u32 s63, s52, 1024
    buffer_load_dwordx4 v5, s[28:31], s63 offen sc1 lds
    s_add_u32 s52, s61, 7
    s_and_b32 s52, s52, 7
    s_lshl_b32 s52, s52, 13
    s_add_u32 s52, s52, s48
    s_add_u32 m0, s51, 57344
    s_nop 0
    buffer_load_dwordx4 v5, s[28:31], s52 offen sc1 lds
    s_add_u32 m0, s51, 58368
    s_add_u32 s63, s52, 1024
    buffer_load_dwordx4 v5, s[28:31], s63 offen sc1 lds
    s_waitcnt vmcnt(12)
    s_barrier
    s_waitcnt vmcnt(8)
    s_barrier
    s_waitcnt vmcnt(4)
    s_barrier
    s_lshl_b32 s47, s25, 2
    s_add_u32 s47, s47, s46
    s_lshl_b32 s47, s47, 14
    s_add_u32 s62, s47, 8192
    v_lshlrev_b32 v10, 7, v0
    s_mov_b32 s52, s14
    s_mov_b32 s53, s15
    s_mov_b32 s54, 0x158000
    s_mov_b32 s55, 0x20000
    buffer_load_dword v12, v10, s[52:55], s47 offen
    buffer_load_dword v13, v10, s[52:55], s62 offen
    s_waitcnt vmcnt(2)
    s_barrier
    s_barrier
    s_mov_b32 s28, s12
    s_mov_b32 s29, s13
    s_mov_b32 s30, 0x158000
    s_mov_b32 s31, 0x20000
    s_mov_b32 s32, s14
    s_mov_b32 s33, s15
    s_mov_b32 s34, 0x158000
    s_mov_b32 s35, 0x20000
    s_mul_i32 s49, s59, 192
    s_and_b32 s61, s58, 1
    s_lshl_b32 s61, s61, 2
    s_add_u32 s61, s61, s59
    s_cmp_eq_u32 s59, 15
    s_cbranch_scc1 L_p4idle
    s_add_u32 s52, s61, 0
    s_and_b32 s52, s52, 7
    s_mul_i32 s52, s52, 176128
    s_add_u32 s52, s52, s49
    s_add_u32 m0, s50, 90112
    s_nop 0
    buffer_load_dwordx4 v20, s[28:31], s52 offen lds
    s_add_u32 m0, s50, 94208
    s_nop 0
    buffer_load_dwordx4 v21, s[28:31], s52 offen lds
    s_add_u32 m0, s50, 98304
    s_nop 0
    buffer_load_dwordx4 v22, s[28:31], s52 offen lds
    s_add_u32 m0, s50, 102400
    s_nop 0
    buffer_load_dwordx4 v23, s[32:35], s52 offen lds
    s_add_u32 m0, s50, 106496
    s_nop 0
    buffer_load_dwordx4 v24, s[32:35], s52 offen lds
    s_add_u32 m0, s50, 110592
    s_nop 0
    buffer_load_dwordx4 v25, s[32:35], s52 offen lds
    s_add_u32 s52, s61, 1
    s_and_b32 s52, s52, 7
    s_mul_i32 s52, s52, 176128
    s_add_u32 s52, s52, s49
    s_add_u32 m0, s50, 114688
    s_nop 0
    buffer_load_dwordx4 v20, s[28:31], s52 offen lds
    s_add_u32 m0, s50, 118784
    s_nop 0
    buffer_load_dwordx4 v21, s[28:31], s52 offen lds
    s_add_u32 m0, s50, 122880
    s_nop 0
    buffer_load_dwordx4 v22, s[28:31], s52 offen lds
    s_add_u32 m0, s50, 126976
    s_nop 0
    buffer_load_dwordx4 v23, s[32:35], s52 offen lds
    s_add_u32 m0, s50, 131072
    s_nop 0
    buffer_load_dwordx4 v24, s[32:35], s52 offen lds
    s_add_u32 m0, s50, 135168
    s_nop 0
    buffer_load_dwordx4 v25, s[32:35], s52 offen lds
    s_add_u32 s52, s61, 2
    s_and_b32 s52, s52, 7
    s_mul_i32 s52, s52, 176128
    s_add_u32 s52, s52, s49
    s_add_u32 m0, s50, 139264
    s_nop 0
    buffer_load_dwordx4 v20, s[28:31], s52 offen lds
    s_add_u32 m0, s50, 143360
    s_nop 0
    buffer_load_dwordx4 v21, s[28:31], s52 offen lds
    s_add_u32 m0, s50, 147456
    s_nop 0
    buffer_load_dwordx4 v22, s[28:31], s52 offen lds
    s_add_u32 m0, s50, 151552
    s_nop 0
    buffer_load_dwordx4 v23, s[32:35], s52 offen lds
    s_add_u32 m0, s50, 155648
    s_nop 0
    buffer_load_dwordx4 v24, s[32:35], s52 offen lds
    s_add_u32 m0, s50, 159744
    s_nop 0
    buffer_load_dwordx4 v25, s[32:35], s52 offen lds
    s_barrier
    s_barrier
    s_lshl_b32 s47, s56, 3
    s_add_u32 s47, s47, s57
    s_cmp_eq_u32 s3, 8
    s_cbranch_scc0 fl_4
    s_lshr_b32 s43, s47, 4
    s_lshl_b32 s43, s43, 7
    s_and_b32 s42, s47, 15
    s_lshl_b32 s42, s42, 2
    s_add_u32 s43, s43, s42
    s_add_u32 s43, s43, 65536
    v_mov_b32 v10, s26
    v_mov_b32 v11, 0
    s_mov_b64 s[40:41], exec
    s_mov_b64 exec, 1
    s_cmp_eq_u32 s27, 0
    s_cbranch_scc1 tw_5
    buffer_store_dword v10, v11, s[36:39], s43 offen
tw_5_e:
    s_mov_b64 exec, s[40:41]
fl_4:
    s_lshl_b32 s47, s58, 7
    s_add_u32 s47, s47, 65536
    v_lshl_add_u32 v10, v0, 2, s47
    s_mov_b64 s[40:41], exec
    s_mov_b64 exec, 0xffff
    s_mov_b32 s42, 0
poll3:
    buffer_load_dword v11, v10, s[36:39], 0 offen sc1
    s_waitcnt vmcnt(0)
    v_cmp_ne_u32 vcc, s26, v11
    s_cbranch_vccz poll3_done
    s_sleep 1
    s_add_u32 s42, s42, 1
    s_cmp_lt_u32 s42, 20000
    s_cbranch_scc1 poll3
poll3_done:
    s_mov_b64 exec, s[40:41]
    s_add_u32 s36, s22, 0x700000
    s_addc_u32 s37, s23, 0
    s_mov_b32 s38, 0x200000
    s_mov_b32 s39, 0x20000
    s_lshl_b32 s48, s58, 1
    s_lshr_b32 s47, s46, 1
    s_add_u32 s48, s48, s47
    s_lshl_b32 s48, s48, 16
    s_and_b32 s47, s46, 1
    s_lshl_b32 s47, s47, 12
    s_add_u32 s48, s48, s47
    s_lshl_b32 s51, s46, 12
    s_add_u32 s53, s61, 0
    s_and_b32 s53, s53, 7
    s_lshl_b32 s53, s53, 13
    s_add_u32 s53, s53, s48
    s_add_u32 m0, s51, 0
    s_nop 0
    buffer_load_dwordx4 v5, s[36:39], s53 offen sc1 lds
    s_add_u32 m0, s51, 1024
    s_add_u32 s63, s53, 1024
    buffer_load_dwordx4 v5, s[36:39], s63 offen sc1 lds
    s_add_u32 m0, s51, 2048
    s_add_u32 s63, s53, 2048
    buffer_load_dwordx4 v5, s[36:39], s63 offen sc1 lds
    s_add_u32 m0, s51, 3072
    s_add_u32 s63, s53, 3072
    buffer_load_dwordx4 v5, s[36:39], s63 offen sc1 lds
    s_add_u32 s53, s61, 1
    s_and_b32 s53, s53, 7
    s_lshl_b32 s53, s53, 13
    s_add_u32 s53, s53, s48
    s_add_u32 m0, s51, 16384
    s_nop 0
    buffer_load_dwordx4 v5, s[36:39], s53 offen sc1 lds
    s_add_u32 m0, s51, 17408
    s_add_u32 s63, s53, 1024
    buffer_load_dwordx4 v5, s[36:39], s63 offen sc1 lds
    s_add_u32 m0, s51, 18432
    s_add_u32 s63, s53, 2048
    buffer_load_dwordx4 v5, s[36:39], s63 offen sc1 lds
    s_add_u32 m0, s51, 19456
    s_add_u32 s63, s53, 3072
    buffer_load_dwordx4 v5, s[36:39], s63 offen sc1 lds
    s_add_u32 s53, s61, 2
    s_and_b32 s53, s53, 7
    s_lshl_b32 s53, s53, 13
    s_add_u32 s53, s53, s48
    s_add_u32 m0, s51, 32768
    s_nop 0
    buffer_load_dwordx4 v5, s[36:39], s53 offen sc1 lds
    s_add_u32 m0, s51, 33792
    s_add_u32 s63, s53, 1024
    buffer_load_dwordx4 v5, s[36:39], s63 offen sc1 lds
    s_add_u32 m0, s51, 34816
    s_add_u32 s63, s53, 2048
    buffer_load_dwordx4 v5, s[36:39], s63 offen sc1 lds
    s_add_u32 m0, s51, 35840
    s_add_u32 s63, s53, 3072
    buffer_load_dwordx4 v5, s[36:39], s63 offen sc1 lds
    s_waitcnt vmcnt(8)
    s_barrier
    s_waitcnt vmcnt(4)
    s_barrier
    s_add_u32 s53, s61, 3
    s_and_b32 s53, s53, 7
    s_lshl_b32 s53, s53, 13
    s_add_u32 s53, s53, s48
    s_add_u32 m0, s51, 0
    s_nop 0
    buffer_load_dwordx4 v5, s[36:39], s53 offen sc1 lds
    s_add_u32 m0, s51, 1024
    s_add_u32 s63, s53, 1024
    buffer_load_dwordx4 v5, s[36:39], s63 offen sc1 lds
    s_add_u32 m0, s51, 2048
    s_add_u32 s63, s53, 2048
    buffer_load_dwordx4 v5, s[36:39], s63 offen sc1 lds
    s_add_u32 m0, s51, 3072
    s_add_u32 s63, s53, 3072
    buffer_load_dwordx4 v5, s[36:39], s63 offen sc1 lds
    s_add_u32 s52, s61, 3
    s_and_b32 s52, s52, 7
    s_mul_i32 s52, s52, 176128
    s_add_u32 s52, s52, s49
    s_add_u32 m0, s50, 90112
    s_nop 0
    buffer_load_dwordx4 v20, s[28:31], s52 offen lds
    s_add_u32 m0, s50, 94208
    s_nop 0
    buffer_load_dwordx4 v21, s[28:31], s52 offen lds
    s_add_u32 m0, s50, 98304
    s_nop 0
    buffer_load_dwordx4 v22, s[28:31], s52 offen lds
    s_add_u32 m0, s50, 102400
    s_nop 0
    buffer_load_dwordx4 v23, s[32:35], s52 offen lds
    s_add_u32 m0, s50, 106496
    s_nop 0
    buffer_load_dwordx4 v24, s[32:35], s52 offen lds
    s_add_u32 m0, s50, 110592
    s_nop 0
    buffer_load_dwordx4 v25, s[32:35], s52 offen lds
    s_waitcnt vmcnt(10)
    s_barrier
    s_add_u32 s53, s61, 4
    s_and_b32 s53, s53, 7
    s_lshl_b32 s53, s53, 13
    s_add_u32 s53, s53, s48
    s_add_u32 m0, s51, 16384
    s_nop 0
    buffer_load_dwordx4 v5, s[36:39], s53 offen sc1 lds
    s_add_u32 m0, s51, 17408
    s_add_u32 s63, s53, 1024
    buffer_load_dwordx4 v5, s[36:39], s63 offen sc1 lds
    s_add_u32 m0, s51, 18432
    s_add_u32 s63, s53, 2048
    buffer_load_dwordx4 v5, s[36:39], s63 offen sc1 lds
    s_add_u32 m0, s51, 19456
    s_add_u32 s63, s53, 3072
    buffer_load_dwordx4 v5, s[36:39], s63 offen sc1 lds
    s_add_u32 s52, s61, 4
    s_and_b32 s52, s52, 7
    s_mul_i32 s52, s52, 176128
    s_add_u32 s52, s52, s49
    s_add_u32 m0, s50, 114688
    s_nop 0
    buffer_load_dwordx4 v20, s[28:31], s52 offen lds
    s_add_u32 m0, s50, 118784
    s_nop 0
    buffer_load_dwordx4 v21, s[28:31], s52 offen lds
    s_add_u32 m0, s50, 122880
    s_nop 0
    buffer_load_dwordx4 v22, s[28:31], s52 offen lds
    s_add_u32 m0, s50, 126976
    s_nop 0
    buffer_load_dwordx4 v23, s[32:35], s52 offen lds
    s_add_u32 m0, s50, 131072
    s_nop 0
    buffer_load_dwordx4 v24, s[32:35], s52 offen lds
    s_add_u32 m0, s50, 135168
    s_nop 0
    buffer_load_dwordx4 v25, s[32:35], s52 offen lds
    s_waitcnt vmcnt(10)
    s_barrier
    s_add_u32 s53, s61, 5
    s_and_b32 s53, s53, 7
    s_lshl_b32 s53, s53, 13
    s_add_u32 s53, s53, s48
    s_add_u32 m0, s51, 32768
    s_nop 0
    buffer_load_dwordx4 v5, s[36:39], s53 offen sc1 lds
    s_add_u32 m0, s51, 33792
    s_add_u32 s63, s53, 1024
    buffer_load_dwordx4 v5, s[36:39], s63 offen sc1 lds
    s_add_u32 m0, s51, 34816
    s_add_u32 s63, s53, 2048
    buffer_load_dwordx4 v5, s[36:39], s63 offen sc1 lds
    s_add_u32 m0, s51, 35840
    s_add_u32 s63, s53, 3072
    buffer_load_dwordx4 v5, s[36:39], s63 offen sc1 lds
    s_add_u32 s52, s61, 5
    s_and_b32 s52, s52, 7
    s_mul_i32 s52, s52, 176128
    s_add_u32 s52, s52, s49
    s_add_u32 m0, s50, 139264
    s_nop 0
    buffer_load_dwordx4 v20, s[28:31], s52 offen lds
    s_add_u32 m0, s50, 143360
    s_nop 0
    buffer_load_dwordx4 v21, s[28:31], s52 offen lds
    s_add_u32 m0, s50, 147456
    s_nop 0
    buffer_load_dwordx4 v22, s[28:31], s52 offen lds
    s_add_u32 m0, s50, 151552
    s_nop 0
    buffer_load_dwordx4 v23, s[32:35], s52 offen lds
    s_add_u32 m0, s50, 155648
    s_nop 0
    buffer_load_dwordx4 v24, s[32:35], s52 offen lds
    s_add_u32 m0, s50, 159744
    s_nop 0
    buffer_load_dwordx4 v25, s[32:35], s52 offen lds
    s_waitcnt vmcnt(10)
    s_barrier
    s_add_u32 s53, s61, 6
    s_and_b32 s53, s53, 7
    s_lshl_b32 s53, s53, 13
    s_add_u32 s53, s53, s48
    s_add_u32 m0, s51, 0
    s_nop 0
    buffer_load_dwordx4 v5, s[36:39], s53 offen sc1 lds
    s_add_u32 m0, s51, 1024
    s_add_u32 s63, s53, 1024
    buffer_load_dwordx4 v5, s[36:39], s63 offen sc1 lds
    s_add_u32 m0, s51, 2048
    s_add_u32 s63, s53, 2048
    buffer_load_dwordx4 v5, s[36:39], s63 offen sc1 lds
    s_add_u32 m0, s51, 3072
    s_add_u32 s63, s53, 3072
    buffer_load_dwordx4 v5, s[36:39], s63 offen sc1 lds
    s_add_u32 s52, s61, 6
    s_and_b32 s52, s52, 7
    s_mul_i32 s52, s52, 176128
    s_add_u32 s52, s52, s49
    s_add_u32 m0, s50, 90112
    s_nop 0
    buffer_load_dwordx4 v20, s[28:31], s52 offen lds
    s_add_u32 m0, s50, 94208
    s_nop 0
    buffer_load_dwordx4 v21, s[28:31], s52 offen lds
    s_add_u32 m0, s50, 98304
    s_nop 0
    buffer_load_dwordx4 v22, s[28:31], s52 offen lds
    s_add_u32 m0, s50, 102400
    s_nop 0
    buffer_load_dwordx4 v23, s[32:35], s52 offen lds
    s_add_u32 m0, s50, 106496
    s_nop 0
    buffer_load_dwordx4 v24, s[32:35], s52 offen lds
    s_add_u32 m0, s50, 110592
    s_nop 0
    buffer_load_dwordx4 v25, s[32:35], s52 offen lds
    s_waitcnt vmcnt(10)
    s_barrier
    s_add_u32 s53, s61, 7
    s_and_b32 s53, s53, 7
    s_lshl_b32 s53, s53, 13
    s_add_u32 s53, s53, s48
    s_add_u32 m0, s51, 16384
    s_nop 0
    buffer_load_dwordx4 v5, s[36:39], s53 offen sc1 lds
    s_add_u32 m0, s51, 17408
    s_add_u32 s63, s53, 1024
    buffer_load_dwordx4 v5, s[36:39], s63 offen sc1 lds
    s_add_u32 m0, s51, 18432
    s_add_u32 s63, s53, 2048
    buffer_load_dwordx4 v5, s[36:39], s63 offen sc1 lds
    s_add_u32 m0, s51, 19456
    s_add_u32 s63, s53, 3072
    buffer_load_dwordx4 v5, s[36:39], s63 offen sc1 lds
    s_add_u32 s52, s61, 7
    s_and_b32 s52, s52, 7
    s_mul_i32 s52, s52, 176128
    s_add_u32 s52, s52, s49
    s_add_u32 m0, s50, 114688
    s_nop 0
    buffer_load_dwordx4 v20, s[28:31], s52 offen lds
    s_add_u32 m0, s50, 118784
    s_nop 0
    buffer_load_dwordx4 v21, s[28:31], s52 offen lds
    s_add_u32 m0, s50, 122880
    s_nop 0
    buffer_load_dwordx4 v22, s[28:31], s52 offen lds
    s_add_u32 m0, s50, 126976
    s_nop 0
    buffer_load_dwordx4 v23, s[32:35], s52 offen lds
    s_add_u32 m0, s50, 131072
    s_nop 0
    buffer_load_dwordx4 v24, s[32:35], s52 offen lds
    s_add_u32 m0, s50, 135168
    s_nop 0
    buffer_load_dwordx4 v25, s[32:35], s52 offen lds
    s_waitcnt vmcnt(10)
    s_barrier
    s_waitcnt vmcnt(0)
    s_barrier
    s_barrier
    s_mov_b32 s32, s16
    s_mov_b32 s33, s17
    s_mov_b32 s34, 0x158000
    s_mov_b32 s35, 0x20000
    s_lshl_b32 s49, s46, 13
    s_lshl_b32 s47, s57, 7
    s_add_u32 s49, s49, s47
    s_and_b32 s60, s56, 3
    s_mul_i32 s60, s60, 11
    s_add_u32 s60, s60, 1
    s_lshr_b32 s60, s60, 1
    s_add_u32 s52, s60, 0
    s_cmp_ge_u32 s52, 22
    s_cselect_b32 s47, 22, 0
    s_sub_u32 s52, s52, s47
    s_lshl_b32 s52, s52, 16
    s_add_u32 s52, s52, s49
    s_add_u32 m0, s50, 98304
    s_nop 0
    buffer_load_dwordx4 v4, s[32:35], s52 offen lds
    s_add_u32 m0, s50, 102400
    s_add_u32 s63, s52, 32768
    buffer_load_dwordx4 v4, s[32:35], s63 offen lds
    s_add_u32 s52, s60, 1
    s_cmp_ge_u32 s52, 22
    s_cselect_b32 s47, 22, 0
    s_sub_u32 s52, s52, s47
    s_lshl_b32 s52, s52, 16
    s_add_u32 s52, s52, s49
    s_add_u32 m0, s50, 106496
    s_nop 0
    buffer_load_dwordx4 v4, s[32:35], s52 offen lds
    s_add_u32 m0, s50, 110592
    s_add_u32 s63, s52, 32768
    buffer_load_dwordx4 v4, s[32:35], s63 offen lds
    s_add_u32 s52, s60, 2
    s_cmp_ge_u32 s52, 22
    s_cselect_b32 s47, 22, 0
    s_sub_u32 s52, s52, s47
    s_lshl_b32 s52, s52, 16
    s_add_u32 s52, s52, s49
    s_add_u32 m0, s50, 114688
    s_nop 0
    buffer_load_dwordx4 v4, s[32:35], s52 offen lds
    s_add_u32 m0, s50, 118784
    s_add_u32 s63, s52, 32768
    buffer_load_dwordx4 v4, s[32:35], s63 offen lds
    s_add_u32 s52, s60, 3
    s_cmp_ge_u32 s52, 22
    s_cselect_b32 s47, 22, 0
    s_sub_u32 s52, s52, s47
    s_lshl_b32 s52, s52, 16
    s_add_u32 s52, s52, s49
    s_add_u32 m0, s50, 122880
    s_nop 0
    buffer_load_dwordx4 v4, s[32:35], s52 offen lds
    s_add_u32 m0, s50, 126976
    s_add_u32 s63, s52, 32768
    buffer_load_dwordx4 v4, s[32:35], s63 offen lds
    s_add_u32 s52, s60, 4
    s_cmp_ge_u32 s52, 22
    s_cselect_b32 s47, 22, 0
    s_sub_u32 s52, s52, s47
    s_lshl_b32 s52, s52, 16
    s_add_u32 s52, s52, s49
    s_add_u32 m0, s50, 131072
    s_nop 0
    buffer_load_dwordx4 v4, s[32:35], s52 offen lds
    s_add_u32 m0, s50, 135168
    s_add_u32 s63, s52, 32768
    buffer_load_dwordx4 v4, s[32:35], s63 offen lds
    s_add_u32 s52, s60, 5
    s_cmp_ge_u32 s52, 22
    s_cselect_b32 s47, 22, 0
    s_sub_u32 s52, s52, s47
    s_lshl_b32 s52, s52, 16
    s_add_u32 s52, s52, s49
    s_add_u32 m0, s50, 139264
    s_nop 0
    buffer_load_dwordx4 v4, s[32:35], s52 offen lds
    s_add_u32 m0, s50, 143360
    s_add_u32 s63, s52, 32768
    buffer_load_dwordx4 v4, s[32:35], s63 offen lds
    s_add_u32 s52, s60, 6
    s_cmp_ge_u32 s52, 22
    s_cselect_b32 s47, 22, 0
    s_sub_u32 s52, s52, s47
    s_lshl_b32 s52, s52, 16
    s_add_u32 s52, s52, s49
    s_add_u32 m0, s50, 147456
    s_nop 0
    buffer_load_dwordx4 v4, s[32:35], s52 offen lds
    s_add_u32 m0, s50, 151552
    s_add_u32 s63, s52, 32768
    buffer_load_dwordx4 v4, s[32:35], s63 offen lds
    s_add_u32 s52, s60, 7
    s_cmp_ge_u32 s52, 22
    s_cselect_b32 s47, 22, 0
    s_sub_u32 s52, s52, s47
    s_lshl_b32 s52, s52, 16
    s_add_u32 s52, s52, s49
    s_add_u32 m0, s50, 155648
    s_nop 0
    buffer_load_dwordx4 v4, s[32:35], s52 offen lds
    s_add_u32 m0, s50, 159744
    s_add_u32 s63, s52, 32768
    buffer_load_dwordx4 v4, s[32:35], s63 offen lds
    s_barrier
    s_barrier
    s_mov_b32 s36, s22
    s_mov_b32 s37, s23
    s_mov_b32 s38, 0x20000
    s_mov_b32 s39, 0x20000
    s_lshl_b32 s47, s58, 4
    s_add_u32 s47, s47, s59
    s_cmp_eq_u32 s3, 8
    s_cbranch_scc0 fl_6
    s_lshr_b32 s43, s47, 4
    s_lshl_b32 s43, s43, 7
    s_and_b32 s42, s47, 15
    s_lshl_b32 s42, s42, 2
    s_add_u32 s43, s43, s42
    s_add_u32 s43, s43, 98304
    v_mov_b32 v10, s26
    v_mov_b32 v11, 0
    s_mov_b64 s[40:41], exec
    s_mov_b64 exec, 1
    s_cmp_eq_u32 s27, 0
    s_cbranch_scc1 tw_7
    buffer_store_dword v10, v11, s[36:39], s43 offen
tw_7_e:
    s_mov_b64 exec, s[40:41]
fl_6:
    s_branch L_p5
L_p4idle:
    s_mov_b32 s32, s16
    s_mov_b32 s33, s17
    s_mov_b32 s34, 0x158000
    s_mov_b32 s35, 0x20000
    s_lshl_b32 s49, s46, 13
    s_lshl_b32 s47, s57, 7
    s_add_u32 s49, s49, s47
    s_and_b32 s60, s56, 3
    s_mul_i32 s60, s60, 11
    s_add_u32 s60, s60, 1
    s_lshr_b32 s60, s60, 1
    s_add_u32 s52, s60, 0
    s_cmp_ge_u32 s52, 22
    s_cselect_b32 s47, 22, 0
    s_sub_u32 s52, s52, s47
    s_lshl_b32 s52, s52, 16
    s_add_u32 s52, s52, s49
    s_add_u32 m0, s50, 98304
    s_nop 0
    buffer_load_dwordx4 v4, s[32:35], s52 offen lds
    s_add_u32 m0, s50, 102400
    s_add_u32 s63, s52, 32768
    buffer_load_dwordx4 v4, s[32:35], s63 offen lds
    s_add_u32 s52, s60, 1
    s_cmp_ge_u32 s52, 22
    s_cselect_b32 s47, 22, 0
    s_sub_u32 s52, s52, s47
    s_lshl_b32 s52, s52, 16
    s_add_u32 s52, s52, s49
    s_add_u32 m0, s50, 106496
    s_nop 0
    buffer_load_dwordx4 v4, s[32:35], s52 offen lds
    s_add_u32 m0, s50, 110592
    s_add_u32 s63, s52, 32768
    buffer_load_dwordx4 v4, s[32:35], s63 offen lds
    s_add_u32 s52, s60, 2
    s_cmp_ge_u32 s52, 22
    s_cselect_b32 s47, 22, 0
    s_sub_u32 s52, s52, s47
    s_lshl_b32 s52, s52, 16
    s_add_u32 s52, s52, s49
    s_add_u32 m0, s50, 114688
    s_nop 0
    buffer_load_dwordx4 v4, s[32:35], s52 offen lds
    s_add_u32 m0, s50, 118784
    s_add_u32 s63, s52, 32768
    buffer_load_dwordx4 v4, s[32:35], s63 offen lds
    s_add_u32 s52, s60, 3
    s_cmp_ge_u32 s52, 22
    s_cselect_b32 s47, 22, 0
    s_sub_u32 s52, s52, s47
    s_lshl_b32 s52, s52, 16
    s_add_u32 s52, s52, s49
    s_add_u32 m0, s50, 122880
    s_nop 0
    buffer_load_dwordx4 v4, s[32:35], s52 offen lds
    s_add_u32 m0, s50, 126976
    s_add_u32 s63, s52, 32768
    buffer_load_dwordx4 v4, s[32:35], s63 offen lds
    s_add_u32 s52, s60, 4
    s_cmp_ge_u32 s52, 22
    s_cselect_b32 s47, 22, 0
    s_sub_u32 s52, s52, s47
    s_lshl_b32 s52, s52, 16
    s_add_u32 s52, s52, s49
    s_add_u32 m0, s50, 131072
    s_nop 0
    buffer_load_dwordx4 v4, s[32:35], s52 offen lds
    s_add_u32 m0, s50, 135168
    s_add_u32 s63, s52, 32768
    buffer_load_dwordx4 v4, s[32:35], s63 offen lds
    s_add_u32 s52, s60, 5
    s_cmp_ge_u32 s52, 22
    s_cselect_b32 s47, 22, 0
    s_sub_u32 s52, s52, s47
    s_lshl_b32 s52, s52, 16
    s_add_u32 s52, s52, s49
    s_add_u32 m0, s50, 139264
    s_nop 0
    buffer_load_dwordx4 v4, s[32:35], s52 offen lds
    s_add_u32 m0, s50, 143360
    s_add_u32 s63, s52, 32768
    buffer_load_dwordx4 v4, s[32:35], s63 offen lds
    s_add_u32 s52, s60, 6
    s_cmp_ge_u32 s52, 22
    s_cselect_b32 s47, 22, 0
    s_sub_u32 s52, s52, s47
    s_lshl_b32 s52, s52, 16
    s_add_u32 s52, s52, s49
    s_add_u32 m0, s50, 147456
    s_nop 0
    buffer_load_dwordx4 v4, s[32:35], s52 offen lds
    s_add_u32 m0, s50, 151552
    s_add_u32 s63, s52, 32768
    buffer_load_dwordx4 v4, s[32:35], s63 offen lds
    s_add_u32 s52, s60, 7
    s_cmp_ge_u32 s52, 22
    s_cselect_b32 s47, 22, 0
    s_sub_u32 s52, s52, s47
    s_lshl_b32 s52, s52, 16
    s_add_u32 s52, s52, s49
    s_add_u32 m0, s50, 155648
    s_nop 0
    buffer_load_dwordx4 v4, s[32:35], s52 offen lds
    s_add_u32 m0, s50, 159744
    s_add_u32 s63, s52, 32768
    buffer_load_dwordx4 v4, s[32:35], s63 offen lds
    s_barrier
    s_barrier
    s_lshl_b32 s47, s56, 3
    s_add_u32 s47, s47, s57
    s_cmp_eq_u32 s3, 8
    s_cbranch_scc0 fl_8
    s_lshr_b32 s43, s47, 4
    s_lshl_b32 s43, s43, 7
    s_and_b32 s42, s47, 15
    s_lshl_b32 s42, s42, 2
    s_add_u32 s43, s43, s42
    s_add_u32 s43, s43, 65536
    v_mov_b32 v10, s26
    v_mov_b32 v11, 0
    s_mov_b64 s[40:41], exec
    s_mov_b64 exec, 1
    s_cmp_eq_u32 s27, 0
    s_cbranch_scc1 tw_9
    buffer_store_dword v10, v11, s[36:39], s43 offen
tw_9_e:
    s_mov_b64 exec, s[40:41]
fl_8:
L_p5:
    s_lshr_b32 s47, s56, 1
    s_lshl_b32 s47, s47, 7
    s_add_u32 s47, s47, 98304
    v_lshl_add_u32 v10, v0, 2, s47
    s_mov_b64 s[40:41], exec
    s_mov_b64 exec, 0x7fff
    s_mov_b32 s42, 0
poll4:
    buffer_load_dword v11, v10, s[36:39], 0 offen sc1
    s_waitcnt vmcnt(0)
    v_cmp_ne_u32 vcc, s26, v11
    s_cbranch_vccz poll4_done
    s_sleep 1
    s_add_u32 s42, s42, 1
    s_cmp_lt_u32 s42, 20000
    s_cbranch_scc1 poll4
poll4_done:
    s_mov_b64 exec, s[40:41]
    s_add_u32 s28, s22, 0x900000
    s_addc_u32 s29, s23, 0
    s_mov_b32 s30, 0x580000
    s_mov_b32 s31, 0x20000
    s_mul_i32 s48, s56, 180224
    s_lshl_b32 s47, s46, 11
    s_add_u32 s48, s48, s47
    s_lshl_b32 s51, s46, 11
    s_add_u32 s53, s60, 0
    s_cmp_ge_u32 s53, 22
    s_cselect_b32 s47, 22, 0
    s_sub_u32 s53, s53, s47
    s_lshl_b32 s53, s53, 13
    s_add_u32 s53, s53, s48
    s_add_u32 m0, s51, 0
    s_nop 0
    buffer_load_dwordx4 v5, s[28:31], s53 offen sc1 lds
    s_add_u32 m0, s51, 1024
    s_add_u32 s63, s53, 1024
    buffer_load_dwordx4 v5, s[28:31], s63 offen sc1 lds
    s_add_u32 s53, s60, 1
    s_cmp_ge_u32 s53, 22
    s_cselect_b32 s47, 22, 0
    s_sub_u32 s53, s53, s47
    s_lshl_b32 s53, s53, 13
    s_add_u32 s53, s53, s48
    s_add_u32 m0, s51, 8192
    s_nop 0
    buffer_load_dwordx4 v5, s[28:31], s53 offen sc1 lds
    s_add_u32 m0, s51, 9216
    s_add_u32 s63, s53, 1024
    buffer_load_dwordx4 v5, s[28:31], s63 offen sc1 lds
    s_add_u32 s53, s60, 2
    s_cmp_ge_u32 s53, 22
    s_cselect_b32 s47, 22, 0
    s_sub_u32 s53, s53, s47
    s_lshl_b32 s53, s53, 13
    s_add_u32 s53, s53, s48
    s_add_u32 m0, s51, 16384
    s_nop 0
    buffer_load_dwordx4 v5, s[28:31], s53 offen sc1 lds
    s_add_u32 m0, s51, 17408
    s_add_u32 s63, s53, 1024
    buffer_load_dwordx4 v5, s[28:31], s63 offen sc1 lds
    s_add_u32 s53, s60, 3
    s_cmp_ge_u32 s53, 22
    s_cselect_b32 s47, 22, 0
    s_sub_u32 s53, s53, s47
    s_lshl_b32 s53, s53, 13
    s_add_u32 s53, s53, s48
    s_add_u32 m0, s51, 24576
    s_nop 0
    buffer_load_dwordx4 v5, s[28:31], s53 offen sc1 lds
    s_add_u32 m0, s51, 25600
    s_add_u32 s63, s53, 1024
    buffer_load_dwordx4 v5, s[28:31], s63 offen sc1 lds
    s_add_u32 s53, s60, 4
    s_cmp_ge_u32 s53, 22
    s_cselect_b32 s47, 22, 0
    s_sub_u32 s53, s53, s47
    s_lshl_b32 s53, s53, 13
    s_add_u32 s53, s53, s48
    s_add_u32 m0, s51, 32768
    s_nop 0
    buffer_load_dwordx4 v5, s[28:31], s53 offen sc1 lds
    s_add_u32 m0, s51, 33792
    s_add_u32 s63, s53, 1024
    buffer_load_dwordx4 v5, s[28:31], s63 offen sc1 lds
    s_add_u32 s53, s60, 5
    s_cmp_ge_u32 s53, 22
    s_cselect_b32 s47, 22, 0
    s_sub_u32 s53, s53, s47
    s_lshl_b32 s53, s53, 13
    s_add_u32 s53, s53, s48
    s_add_u32 m0, s51, 40960
    s_nop 0
    buffer_load_dwordx4 v5, s[28:31], s53 offen sc1 lds
    s_add_u32 m0, s51, 41984
    s_add_u32 s63, s53, 1024
    buffer_load_dwordx4 v5, s[28:31], s63 offen sc1 lds
    s_waitcnt vmcnt(8)
    s_barrier
    s_add_u32 s53, s60, 6
    s_cmp_ge_u32 s53, 22
    s_cselect_b32 s47, 22, 0
    s_sub_u32 s53, s53, s47
    s_lshl_b32 s53, s53, 13
    s_add_u32 s53, s53, s48
    s_add_u32 m0, s51, 49152
    s_nop 0
    buffer_load_dwordx4 v5, s[28:31], s53 offen sc1 lds
    s_add_u32 m0, s51, 50176
    s_add_u32 s63, s53, 1024
    buffer_load_dwordx4 v5, s[28:31], s63 offen sc1 lds
    s_add_u32 s53, s60, 7
    s_cmp_ge_u32 s53, 22
    s_cselect_b32 s47, 22, 0
    s_sub_u32 s53, s53, s47
    s_lshl_b32 s53, s53, 13
    s_add_u32 s53, s53, s48
    s_add_u32 m0, s51, 57344
    s_nop 0
    buffer_load_dwordx4 v5, s[28:31], s53 offen sc1 lds
    s_add_u32 m0, s51, 58368
    s_add_u32 s63, s53, 1024
    buffer_load_dwordx4 v5, s[28:31], s63 offen sc1 lds
    s_waitcnt vmcnt(8)
    s_barrier
    s_add_u32 s53, s60, 8
    s_cmp_ge_u32 s53, 22
    s_cselect_b32 s47, 22, 0
    s_sub_u32 s53, s53, s47
    s_lshl_b32 s53, s53, 13
    s_add_u32 s53, s53, s48
    s_add_u32 m0, s51, 0
    s_nop 0
    buffer_load_dwordx4 v5, s[28:31], s53 offen sc1 lds
    s_add_u32 m0, s51, 1024
    s_add_u32 s63, s53, 1024
    buffer_load_dwordx4 v5, s[28:31], s63 offen sc1 lds
    s_add_u32 s52, s60, 8
    s_cmp_ge_u32 s52, 22
    s_cselect_b32 s47, 22, 0
    s_sub_u32 s52, s52, s47
    s_lshl_b32 s52, s52, 16
    s_add_u32 s52, s52, s49
    s_add_u32 m0, s50, 98304
    s_nop 0
    buffer_load_dwordx4 v4, s[32:35], s52 offen lds
    s_add_u32 m0, s50, 102400
    s_add_u32 s63, s52, 32768
    buffer_load_dwordx4 v4, s[32:35], s63 offen lds
    s_add_u32 s53, s60, 9
    s_cmp_ge_u32 s53, 22
    s_cselect_b32 s47, 22, 0
    s_sub_u32 s53, s53, s47
    s_lshl_b32 s53, s53, 13
    s_add_u32 s53, s53, s48
    s_add_u32 m0, s51, 8192
    s_nop 0
    buffer_load_dwordx4 v5, s[28:31], s53 offen sc1 lds
    s_add_u32 m0, s51, 9216
    s_add_u32 s63, s53, 1024
    buffer_load_dwordx4 v5, s[28:31], s63 offen sc1 lds
    s_add_u32 s52, s60, 9
    s_cmp_ge_u32 s52, 22
    s_cselect_b32 s47, 22, 0
    s_sub_u32 s52, s52, s47
    s_lshl_b32 s52, s52, 16
    s_add_u32 s52, s52, s49
    s_add_u32 m0, s50, 106496
    s_nop 0
    buffer_load_dwordx4 v4, s[32:35], s52 offen lds
    s_add_u32 m0, s50, 110592
    s_add_u32 s63, s52, 32768
    buffer_load_dwordx4 v4, s[32:35], s63 offen lds
    s_waitcnt vmcnt(12)
    s_barrier
    s_add_u32 s53, s60, 10
    s_cmp_ge_u32 s53, 22
    s_cselect_b32 s47, 22, 0
    s_sub_u32 s53, s53, s47
    s_lshl_b32 s53, s53, 13
    s_add_u32 s53, s53, s48
    s_add_u32 m0, s51, 16384
    s_nop 0
    buffer_load_dwordx4 v5, s[28:31], s53 offen sc1 lds
    s_add_u32 m0, s51, 17408
    s_add_u32 s63, s53, 1024
    buffer_load_dwordx4 v5, s[28:31], s63 offen sc1 lds
    s_add_u32 s52, s60, 10
    s_cmp_ge_u32 s52, 22
    s_cselect_b32 s47, 22, 0
    s_sub_u32 s52, s52, s47
    s_lshl_b32 s52, s52, 16
    s_add_u32 s52, s52, s49
    s_add_u32 m0, s50, 114688
    s_nop 0
    buffer_load_dwordx4 v4, s[32:35], s52 offen lds
    s_add_u32 m0, s50, 118784
    s_add_u32 s63, s52, 32768
    buffer_load_dwordx4 v4, s[32:35], s63 offen lds
    s_add_u32 s53, s60, 11
    s_cmp_ge_u32 s53, 22
    s_cselect_b32 s47, 22, 0
    s_sub_u32 s53, s53, s47
    s_lshl_b32 s53, s53, 13
    s_add_u32 s53, s53, s48
    s_add_u32 m0, s51, 24576
    s_nop 0
    buffer_load_dwordx4 v5, s[28:31], s53 offen sc1 lds
    s_add_u32 m0, s51, 25600
    s_add_u32 s63, s53, 1024
    buffer_load_dwordx4 v5, s[28:31], s63 offen sc1 lds
    s_add_u32 s52, s60, 11
    s_cmp_ge_u32 s52, 22
    s_cselect_b32 s47, 22, 0
    s_sub_u32 s52, s52, s47
    s_lshl_b32 s52, s52, 16
    s_add_u32 s52, s52, s49
    s_add_u32 m0, s50, 122880
    s_nop 0
    buffer_load_dwordx4 v4, s[32:35], s52 offen lds
    s_add_u32 m0, s50, 126976
    s_add_u32 s63, s52, 32768
    buffer_load_dwordx4 v4, s[32:35], s63 offen lds
    s_waitcnt vmcnt(16)
    s_barrier
    s_add_u32 s53, s60, 12
    s_cmp_ge_u32 s53, 22
    s_cselect_b32 s47, 22, 0
    s_sub_u32 s53, s53, s47
    s_lshl_b32 s53, s53, 13
    s_add_u32 s53, s53, s48
    s_add_u32 m0, s51, 32768
    s_nop 0
    buffer_load_dwordx4 v5, s[28:31], s53 offen sc1 lds
    s_add_u32 m0, s51, 33792
    s_add_u32 s63, s53, 1024
    buffer_load_dwordx4 v5, s[28:31], s63 offen sc1 lds
    s_add_u32 s52, s60, 12
    s_cmp_ge_u32 s52, 22
    s_cselect_b32 s47, 22, 0
    s_sub_u32 s52, s52, s47
    s_lshl_b32 s52, s52, 16
    s_add_u32 s52, s52, s49
    s_add_u32 m0, s50, 131072
    s_nop 0
    buffer_load_dwordx4 v4, s[32:35], s52 offen lds
    s_add_u32 m0, s50, 135168
    s_add_u32 s63, s52, 32768
    buffer_load_dwordx4 v4, s[32:35], s63 offen lds
    s_add_u32 s53, s60, 13
    s_cmp_ge_u32 s53, 22
    s_cselect_b32 s47, 22, 0
    s_sub_u32 s53, s53, s47
    s_lshl_b32 s53, s53, 13
    s_add_u32 s53, s53, s48
    s_add_u32 m0, s51, 40960
    s_nop 0
    buffer_load_dwordx4 v5, s[28:31], s53 offen sc1 lds
    s_add_u32 m0, s51, 41984
    s_add_u32 s63, s53, 1024
    buffer_load_dwordx4 v5, s[28:31], s63 offen sc1 lds
    s_add_u32 s52, s60, 13
    s_cmp_ge_u32 s52, 22
    s_cselect_b32 s47, 22, 0
    s_sub_u32 s52, s52, s47
    s_lshl_b32 s52, s52, 16
    s_add_u32 s52, s52, s49
    s_add_u32 m0, s50, 139264
    s_nop 0
    buffer_load_dwordx4 v4, s[32:35], s52 offen lds
    s_add_u32 m0, s50, 143360
    s_add_u32 s63, s52, 32768
    buffer_load_dwordx4 v4, s[32:35], s63 offen lds
    s_waitcnt vmcnt(16)
    s_barrier
    s_add_u32 s53, s60, 14
    s_cmp_ge_u32 s53, 22
    s_cselect_b32 s47, 22, 0
    s_sub_u32 s53, s53, s47
    s_lshl_b32 s53, s53, 13
    s_add_u32 s53, s53, s48
    s_add_u32 m0, s51, 49152
    s_nop 0
    buffer_load_dwordx4 v5, s[28:31], s53 offen sc1 lds
    s_add_u32 m0, s51, 50176
    s_add_u32 s63, s53, 1024
    buffer_load_dwordx4 v5, s[28:31], s63 offen sc1 lds
    s_add_u32 s52, s60, 14
    s_cmp_ge_u32 s52, 22
    s_cselect_b32 s47, 22, 0
    s_sub_u32 s52, s52, s47
    s_lshl_b32 s52, s52, 16
    s_add_u32 s52, s52, s49
    s_add_u32 m0, s50, 147456
    s_nop 0
    buffer_load_dwordx4 v4, s[32:35], s52 offen lds
    s_add_u32 m0, s50, 151552
    s_add_u32 s63, s52, 32768
    buffer_load_dwordx4 v4, s[32:35], s63 offen lds
    s_add_u32 s53, s60, 15
    s_cmp_ge_u32 s53, 22
    s_cselect_b32 s47, 22, 0
    s_sub_u32 s53, s53, s47
    s_lshl_b32 s53, s53, 13
    s_add_u32 s53, s53, s48
    s_add_u32 m0, s51, 57344
    s_nop 0
    buffer_load_dwordx4 v5, s[28:31], s53 offen sc1 lds
    s_add_u32 m0, s51, 58368
    s_add_u32 s63, s53, 1024
    buffer_load_dwordx4 v5, s[28:31], s63 offen sc1 lds
    s_add_u32 s52, s60, 15
    s_cmp_ge_u32 s52, 22
    s_cselect_b32 s47, 22, 0
    s_sub_u32 s52, s52, s47
    s_lshl_b32 s52, s52, 16
    s_add_u32 s52, s52, s49
    s_add_u32 m0, s50, 155648
    s_nop 0
    buffer_load_dwordx4 v4, s[32:35], s52 offen lds
    s_add_u32 m0, s50, 159744
    s_add_u32 s63, s52, 32768
    buffer_load_dwordx4 v4, s[32:35], s63 offen lds
    s_waitcnt vmcnt(16)
    s_barrier
    s_add_u32 s53, s60, 16
    s_cmp_ge_u32 s53, 22
    s_cselect_b32 s47, 22, 0
    s_sub_u32 s53, s53, s47
    s_lshl_b32 s53, s53, 13
    s_add_u32 s53, s53, s48
    s_add_u32 m0, s51, 0
    s_nop 0
    buffer_load_dwordx4 v5, s[28:31], s53 offen sc1 lds
    s_add_u32 m0, s51, 1024
    s_add_u32 s63, s53, 1024
    buffer_load_dwordx4 v5, s[28:31], s63 offen sc1 lds
    s_add_u32 s52, s60, 16
    s_cmp_ge_u32 s52, 22
    s_cselect_b32 s47, 22, 0
    s_sub_u32 s52, s52, s47
    s_lshl_b32 s52, s52, 16
    s_add_u32 s52, s52, s49
    s_add_u32 m0, s50, 98304
    s_nop 0
    buffer_load_dwordx4 v4, s[32:35], s52 offen lds
    s_add_u32 m0, s50, 102400
    s_add_u32 s63, s52, 32768
    buffer_load_dwordx4 v4, s[32:35], s63 offen lds
    s_add_u32 s53, s60, 17
    s_cmp_ge_u32 s53, 22
    s_cselect_b32 s47, 22, 0
    s_sub_u32 s53, s53, s47
    s_lshl_b32 s53, s53, 13
    s_add_u32 s53, s53, s48
    s_add_u32 m0, s51, 8192
    s_nop 0
    buffer_load_dwordx4 v5, s[28:31], s53 offen sc1 lds
    s_add_u32 m0, s51, 9216
    s_add_u32 s63, s53, 1024
    buffer_load_dwordx4 v5, s[28:31], s63 offen sc1 lds
    s_add_u32 s52, s60, 17
    s_cmp_ge_u32 s52, 22
    s_cselect_b32 s47, 22, 0
    s_sub_u32 s52, s52, s47
    s_lshl_b32 s52, s52, 16
    s_add_u32 s52, s52, s49
    s_add_u32 m0, s50, 106496
    s_nop 0
    buffer_load_dwordx4 v4, s[32:35], s52 offen lds
    s_add_u32 m0, s50, 110592
    s_add_u32 s63, s52, 32768
    buffer_load_dwordx4 v4, s[32:35], s63 offen lds
    s_waitcnt vmcnt(16)
    s_barrier
    s_add_u32 s53, s60, 18
    s_cmp_ge_u32 s53, 22
    s_cselect_b32 s47, 22, 0
    s_sub_u32 s53, s53, s47
    s_lshl_b32 s53, s53, 13
    s_add_u32 s53, s53, s48
    s_add_u32 m0, s51, 16384
    s_nop 0
    buffer_load_dwordx4 v5, s[28:31], s53 offen sc1 lds
    s_add_u32 m0, s51, 17408
    s_add_u32 s63, s53, 1024
    buffer_load_dwordx4 v5, s[28:31], s63 offen sc1 lds
    s_add_u32 s52, s60, 18
    s_cmp_ge_u32 s52, 22
    s_cselect_b32 s47, 22, 0
    s_sub_u32 s52, s52, s47
    s_lshl_b32 s52, s52, 16
    s_add_u32 s52, s52, s49
    s_add_u32 m0, s50, 114688
    s_nop 0
    buffer_load_dwordx4 v4, s[32:35], s52 offen lds
    s_add_u32 m0, s50, 118784
    s_add_u32 s63, s52, 32768
    buffer_load_dwordx4 v4, s[32:35], s63 offen lds
    s_add_u32 s53, s60, 19
    s_cmp_ge_u32 s53, 22
    s_cselect_b32 s47, 22, 0
    s_sub_u32 s53, s53, s47
    s_lshl_b32 s53, s53, 13
    s_add_u32 s53, s53, s48
    s_add_u32 m0, s51, 24576
    s_nop 0
    buffer_load_dwordx4 v5, s[28:31], s53 offen sc1 lds
    s_add_u32 m0, s51, 25600
    s_add_u32 s63, s53, 1024
    buffer_load_dwordx4 v5, s[28:31], s63 offen sc1 lds
    s_add_u32 s52, s60, 19
    s_cmp_ge_u32 s52, 22
    s_cselect_b32 s47, 22, 0
    s_sub_u32 s52, s52, s47
    s_lshl_b32 s52, s52, 16
    s_add_u32 s52, s52, s49
    s_add_u32 m0, s50, 122880
    s_nop 0
    buffer_load_dwordx4 v4, s[32:35], s52 offen lds
    s_add_u32 m0, s50, 126976
    s_add_u32 s63, s52, 32768
    buffer_load_dwordx4 v4, s[32:35], s63 offen lds
    s_waitcnt vmcnt(16)
    s_barrier
    s_add_u32 s53, s60, 20
    s_cmp_ge_u32 s53, 22
    s_cselect_b32 s47, 22, 0
    s_sub_u32 s53, s53, s47
    s_lshl_b32 s53, s53, 13
    s_add_u32 s53, s53, s48
    s_add_u32 m0, s51, 32768
    s_nop 0
    buffer_load_dwordx4 v5, s[28:31], s53 offen sc1 lds
    s_add_u32 m0, s51, 33792
    s_add_u32 s63, s53, 1024
    buffer_load_dwordx4 v5, s[28:31], s63 offen sc1 lds
    s_add_u32 s52, s60, 20
    s_cmp_ge_u32 s52, 22
    s_cselect_b32 s47, 22, 0
    s_sub_u32 s52, s52, s47
    s_lshl_b32 s52, s52, 16
    s_add_u32 s52, s52, s49
    s_add_u32 m0, s50, 131072
    s_nop 0
    buffer_load_dwordx4 v4, s[32:35], s52 offen lds
    s_add_u32 m0, s50, 135168
    s_add_u32 s63, s52, 32768
    buffer_load_dwordx4 v4, s[32:35], s63 offen lds
    s_add_u32 s53, s60, 21
    s_cmp_ge_u32 s53, 22
    s_cselect_b32 s47, 22, 0
    s_sub_u32 s53, s53, s47
    s_lshl_b32 s53, s53, 13
    s_add_u32 s53, s53, s48
    s_add_u32 m0, s51, 40960
    s_nop 0
    buffer_load_dwordx4 v5, s[28:31], s53 offen sc1 lds
    s_add_u32 m0, s51, 41984
    s_add_u32 s63, s53, 1024
    buffer_load_dwordx4 v5, s[28:31], s63 offen sc1 lds
    s_add_u32 s52, s60, 21
    s_cmp_ge_u32 s52, 22
    s_cselect_b32 s47, 22, 0
    s_sub_u32 s52, s52, s47
    s_lshl_b32 s52, s52, 16
    s_add_u32 s52, s52, s49
    s_add_u32 m0, s50, 139264
    s_nop 0
    buffer_load_dwordx4 v4, s[32:35], s52 offen lds
    s_add_u32 m0, s50, 143360
    s_add_u32 s63, s52, 32768
    buffer_load_dwordx4 v4, s[32:35], s63 offen lds
    s_waitcnt vmcnt(16)
    s_barrier
    s_waitcnt vmcnt(8)
    s_barrier
    s_waitcnt vmcnt(0)
    s_barrier
    s_barrier
    s_endpgm
sequential_preLN__sliding_block__geglu_ffn__prompt_kernel_compute:
    s_cmp_ge_u32 s3, 4
    s_cbranch_scc1 C_p1_aux
    s_and_b32 s46, s3, 1
    s_lshr_b32 s47, s3, 1
    v_and_b32 v109, 31, v0
    v_lshrrev_b32_e64 v110, 5, v0
    v_bfe_u32 v111, v0, 1, 3
    v_xor_b32 v111, v111, v110
    v_lshlrev_b32_e64 v111, 4, v111
    s_lshl_b32 s40, s46, 12
    v_lshl_add_u32 v112, v109, 7, v111
    v_add_u32_e64 v115, s40, v112
    v_bfe_u32 v111, v0, 2, 2
    v_lshl_add_u32 v112, v110, 3, v111
    v_bfe_u32 v113, v0, 4, 1
    v_bfe_u32 v114, v0, 1, 1
    v_lshl_add_u32 v113, v113, 1, v114
    s_lshl_b32 s40, s47, 2
    v_add_u32 v113, s40, v113
    v_bfe_u32 v114, v0, 3, 1
    v_lshlrev_b32 v114, 2, v114
    v_xor_b32 v113, v113, v114
    v_lshlrev_b32_e64 v113, 4, v113
    v_lshl_add_u32 v113, v112, 7, v113
    v_and_b32_e64 v114, 1, v0
    v_lshl_add_u32 v108, v114, 3, v113
    s_lshl_b32 s48, s46, 1
    s_xor_b32 s40, s48, 0
    s_lshl_b32 s41, s40, 5
    v_xor_b32 v100, s41, v115
    s_lshl_b32 s41, s40, 11
    v_add_u32 v104, s41, v108
    s_xor_b32 s40, s48, 1
    s_lshl_b32 s41, s40, 5
    v_xor_b32 v101, s41, v115
    s_lshl_b32 s41, s40, 11
    v_add_u32 v105, s41, v108
    s_xor_b32 s40, s48, 2
    s_lshl_b32 s41, s40, 5
    v_xor_b32 v102, s41, v115
    s_lshl_b32 s41, s40, 11
    v_add_u32 v106, s41, v108
    s_xor_b32 s40, s48, 3
    s_lshl_b32 s41, s40, 5
    v_xor_b32 v103, s41, v115
    s_lshl_b32 s41, s40, 11
    v_add_u32 v107, s41, v108
    v_and_b32 v111, 15, v0
    v_bfe_u32 v112, v0, 4, 1
    v_cmp_eq_u32 s[40:41], v111, v112
    v_mov_b32 v113, 0x3f803f80
    s_nop 0
    v_cndmask_b32_e64 v96, 0, v113, s[40:41]
    v_cndmask_b32_e64 v97, 0, v113, s[40:41]
    v_cndmask_b32_e64 v98, 0, v113, s[40:41]
    v_cndmask_b32_e64 v99, 0, v113, s[40:41]
    s_barrier
    ds_read_b128 v[52:55], v100 offset:0
    ds_read_b64_tr_b16 v[60:61], v104 offset:8192
    ds_read_b64_tr_b16 v[62:63], v104 offset:8704
    ds_read_b64_tr_b16 v[64:65], v104 offset:16384
    ds_read_b64_tr_b16 v[66:67], v104 offset:16896
    ds_read_b64_tr_b16 v[68:69], v104 offset:24576
    ds_read_b64_tr_b16 v[70:71], v104 offset:25088
    s_waitcnt lgkmcnt(4)
    v_mfma_f32_32x32x16_bf16 v[4:19], v[60:63], v[52:55], 0
    ds_read_b128 v[56:59], v101 offset:0
    ds_read_b64_tr_b16 v[72:73], v105 offset:8192
    ds_read_b64_tr_b16 v[74:75], v105 offset:8704
    v_mfma_f32_16x16x32_bf16 v[84:87], v[60:63], v[96:99], 0
    s_waitcnt lgkmcnt(5)
    v_mfma_f32_32x32x16_bf16 v[20:35], v[64:67], v[52:55], 0
    ds_read_b64_tr_b16 v[76:77], v105 offset:16384
    ds_read_b64_tr_b16 v[78:79], v105 offset:16896
    v_mfma_f32_16x16x32_bf16 v[88:91], v[64:67], v[96:99], 0
    s_waitcnt lgkmcnt(5)
    v_mfma_f32_32x32x16_bf16 v[36:51], v[68:71], v[52:55], 0
    ds_read_b64_tr_b16 v[80:81], v105 offset:24576
    ds_read_b64_tr_b16 v[82:83], v105 offset:25088
    v_mfma_f32_16x16x32_bf16 v[92:95], v[68:71], v[96:99], 0
    s_waitcnt lgkmcnt(4)
    v_mfma_f32_32x32x16_bf16 v[4:19], v[72:75], v[56:59], v[4:19]
    ds_read_b128 v[52:55], v102 offset:0
    ds_read_b64_tr_b16 v[60:61], v106 offset:8192
    ds_read_b64_tr_b16 v[62:63], v106 offset:8704
    v_mfma_f32_16x16x32_bf16 v[84:87], v[72:75], v[96:99], v[84:87]
    s_waitcnt lgkmcnt(5)
    v_mfma_f32_32x32x16_bf16 v[20:35], v[76:79], v[56:59], v[20:35]
    ds_read_b64_tr_b16 v[64:65], v106 offset:16384
    ds_read_b64_tr_b16 v[66:67], v106 offset:16896
    v_mfma_f32_16x16x32_bf16 v[88:91], v[76:79], v[96:99], v[88:91]
    s_waitcnt lgkmcnt(5)
    v_mfma_f32_32x32x16_bf16 v[36:51], v[80:83], v[56:59], v[36:51]
    ds_read_b64_tr_b16 v[68:69], v106 offset:24576
    ds_read_b64_tr_b16 v[70:71], v106 offset:25088
    v_mfma_f32_16x16x32_bf16 v[92:95], v[80:83], v[96:99], v[92:95]
    s_waitcnt lgkmcnt(4)
    v_mfma_f32_32x32x16_bf16 v[4:19], v[60:63], v[52:55], v[4:19]
    ds_read_b128 v[56:59], v103 offset:0
    ds_read_b64_tr_b16 v[72:73], v107 offset:8192
    ds_read_b64_tr_b16 v[74:75], v107 offset:8704
    s_waitcnt lgkmcnt(5)
    v_mfma_f32_32x32x16_bf16 v[20:35], v[64:67], v[52:55], v[20:35]
    ds_read_b64_tr_b16 v[76:77], v107 offset:16384
    ds_read_b64_tr_b16 v[78:79], v107 offset:16896
    s_waitcnt lgkmcnt(5)
    v_mfma_f32_32x32x16_bf16 v[36:51], v[68:71], v[52:55], v[36:51]
    ds_read_b64_tr_b16 v[80:81], v107 offset:24576
    ds_read_b64_tr_b16 v[82:83], v107 offset:25088
    s_waitcnt lgkmcnt(0)
    s_barrier
    ds_read_b128 v[52:55], v100 offset:32768
    ds_read_b64_tr_b16 v[60:61], v104 offset:40960
    ds_read_b64_tr_b16 v[62:63], v104 offset:41472
    ds_read_b64_tr_b16 v[64:65], v104 offset:49152
    ds_read_b64_tr_b16 v[66:67], v104 offset:49664
    ds_read_b64_tr_b16 v[68:69], v104 offset:57344
    ds_read_b64_tr_b16 v[70:71], v104 offset:57856
    v_mfma_f32_32x32x16_bf16 v[4:19], v[72:75], v[56:59], v[4:19]
    v_mfma_f32_32x32x16_bf16 v[20:35], v[76:79], v[56:59], v[20:35]
    v_mfma_f32_32x32x16_bf16 v[36:51], v[80:83], v[56:59], v[36:51]
    s_waitcnt lgkmcnt(4)
    v_mfma_f32_32x32x16_bf16 v[4:19], v[60:63], v[52:55], v[4:19]
    ds_read_b128 v[56:59], v101 offset:32768
    ds_read_b64_tr_b16 v[72:73], v105 offset:40960
    ds_read_b64_tr_b16 v[74:75], v105 offset:41472
    v_mfma_f32_16x16x32_bf16 v[84:87], v[60:63], v[96:99], v[84:87]
    s_waitcnt lgkmcnt(5)
    v_mfma_f32_32x32x16_bf16 v[20:35], v[64:67], v[52:55], v[20:35]
    ds_read_b64_tr_b16 v[76:77], v105 offset:49152
    ds_read_b64_tr_b16 v[78:79], v105 offset:49664
    v_mfma_f32_16x16x32_bf16 v[88:91], v[64:67], v[96:99], v[88:91]
    s_waitcnt lgkmcnt(5)
    v_mfma_f32_32x32x16_bf16 v[36:51], v[68:71], v[52:55], v[36:51]
    ds_read_b64_tr_b16 v[80:81], v105 offset:57344
    ds_read_b64_tr_b16 v[82:83], v105 offset:57856
    v_mfma_f32_16x16x32_bf16 v[92:95], v[68:71], v[96:99], v[92:95]
    s_waitcnt lgkmcnt(4)
    v_mfma_f32_32x32x16_bf16 v[4:19], v[72:75], v[56:59], v[4:19]
    ds_read_b128 v[52:55], v102 offset:32768
    ds_read_b64_tr_b16 v[60:61], v106 offset:40960
    ds_read_b64_tr_b16 v[62:63], v106 offset:41472
    v_mfma_f32_16x16x32_bf16 v[84:87], v[72:75], v[96:99], v[84:87]
    s_waitcnt lgkmcnt(5)
    v_mfma_f32_32x32x16_bf16 v[20:35], v[76:79], v[56:59], v[20:35]
    ds_read_b64_tr_b16 v[64:65], v106 offset:49152
    ds_read_b64_tr_b16 v[66:67], v106 offset:49664
    v_mfma_f32_16x16x32_bf16 v[88:91], v[76:79], v[96:99], v[88:91]
    s_waitcnt lgkmcnt(5)
    v_mfma_f32_32x32x16_bf16 v[36:51], v[80:83], v[56:59], v[36:51]
    ds_read_b64_tr_b16 v[68:69], v106 offset:57344
    ds_read_b64_tr_b16 v[70:71], v106 offset:57856
    v_mfma_f32_16x16x32_bf16 v[92:95], v[80:83], v[96:99], v[92:95]
    s_waitcnt lgkmcnt(4)
    v_mfma_f32_32x32x16_bf16 v[4:19], v[60:63], v[52:55], v[4:19]
    ds_read_b128 v[56:59], v103 offset:32768
    ds_read_b64_tr_b16 v[72:73], v107 offset:40960
    ds_read_b64_tr_b16 v[74:75], v107 offset:41472
    s_waitcnt lgkmcnt(5)
    v_mfma_f32_32x32x16_bf16 v[20:35], v[64:67], v[52:55], v[20:35]
    ds_read_b64_tr_b16 v[76:77], v107 offset:49152
    ds_read_b64_tr_b16 v[78:79], v107 offset:49664
    s_waitcnt lgkmcnt(5)
    v_mfma_f32_32x32x16_bf16 v[36:51], v[68:71], v[52:55], v[36:51]
    ds_read_b64_tr_b16 v[80:81], v107 offset:57344
    ds_read_b64_tr_b16 v[82:83], v107 offset:57856
    s_waitcnt lgkmcnt(0)
    s_barrier
    v_add_u32 v100, 0x10000, v100
    v_add_u32 v101, 0x10000, v101
    v_add_u32 v102, 0x10000, v102
    v_add_u32 v103, 0x10000, v103
    v_add_u32 v104, 0x10000, v104
    v_add_u32 v105, 0x10000, v105
    v_add_u32 v106, 0x10000, v106
    v_add_u32 v107, 0x10000, v107
    ds_read_b128 v[52:55], v100 offset:0
    ds_read_b64_tr_b16 v[60:61], v104 offset:8192
    ds_read_b64_tr_b16 v[62:63], v104 offset:8704
    ds_read_b64_tr_b16 v[64:65], v104 offset:16384
    ds_read_b64_tr_b16 v[66:67], v104 offset:16896
    ds_read_b64_tr_b16 v[68:69], v104 offset:24576
    ds_read_b64_tr_b16 v[70:71], v104 offset:25088
    v_mfma_f32_32x32x16_bf16 v[4:19], v[72:75], v[56:59], v[4:19]
    v_mfma_f32_32x32x16_bf16 v[20:35], v[76:79], v[56:59], v[20:35]
    v_mfma_f32_32x32x16_bf16 v[36:51], v[80:83], v[56:59], v[36:51]
    s_waitcnt lgkmcnt(4)
    v_mfma_f32_32x32x16_bf16 v[4:19], v[60:63], v[52:55], v[4:19]
    ds_read_b128 v[56:59], v101 offset:0
    ds_read_b64_tr_b16 v[72:73], v105 offset:8192
    ds_read_b64_tr_b16 v[74:75], v105 offset:8704
    v_mfma_f32_16x16x32_bf16 v[84:87], v[60:63], v[96:99], v[84:87]
    s_waitcnt lgkmcnt(5)
    v_mfma_f32_32x32x16_bf16 v[20:35], v[64:67], v[52:55], v[20:35]
    ds_read_b64_tr_b16 v[76:77], v105 offset:16384
    ds_read_b64_tr_b16 v[78:79], v105 offset:16896
    v_mfma_f32_16x16x32_bf16 v[88:91], v[64:67], v[96:99], v[88:91]
    s_waitcnt lgkmcnt(5)
    v_mfma_f32_32x32x16_bf16 v[36:51], v[68:71], v[52:55], v[36:51]
    ds_read_b64_tr_b16 v[80:81], v105 offset:24576
    ds_read_b64_tr_b16 v[82:83], v105 offset:25088
    v_mfma_f32_16x16x32_bf16 v[92:95], v[68:71], v[96:99], v[92:95]
    s_waitcnt lgkmcnt(4)
    v_mfma_f32_32x32x16_bf16 v[4:19], v[72:75], v[56:59], v[4:19]
    ds_read_b128 v[52:55], v102 offset:0
    ds_read_b64_tr_b16 v[60:61], v106 offset:8192
    ds_read_b64_tr_b16 v[62:63], v106 offset:8704
    v_mfma_f32_16x16x32_bf16 v[84:87], v[72:75], v[96:99], v[84:87]
    s_waitcnt lgkmcnt(5)
    v_mfma_f32_32x32x16_bf16 v[20:35], v[76:79], v[56:59], v[20:35]
    ds_read_b64_tr_b16 v[64:65], v106 offset:16384
    ds_read_b64_tr_b16 v[66:67], v106 offset:16896
    v_mfma_f32_16x16x32_bf16 v[88:91], v[76:79], v[96:99], v[88:91]
    s_waitcnt lgkmcnt(5)
    v_mfma_f32_32x32x16_bf16 v[36:51], v[80:83], v[56:59], v[36:51]
    ds_read_b64_tr_b16 v[68:69], v106 offset:24576
    ds_read_b64_tr_b16 v[70:71], v106 offset:25088
    v_mfma_f32_16x16x32_bf16 v[92:95], v[80:83], v[96:99], v[92:95]
    s_waitcnt lgkmcnt(4)
    v_mfma_f32_32x32x16_bf16 v[4:19], v[60:63], v[52:55], v[4:19]
    ds_read_b128 v[56:59], v103 offset:0
    ds_read_b64_tr_b16 v[72:73], v107 offset:8192
    ds_read_b64_tr_b16 v[74:75], v107 offset:8704
    s_waitcnt lgkmcnt(5)
    v_mfma_f32_32x32x16_bf16 v[20:35], v[64:67], v[52:55], v[20:35]
    ds_read_b64_tr_b16 v[76:77], v107 offset:16384
    ds_read_b64_tr_b16 v[78:79], v107 offset:16896
    s_waitcnt lgkmcnt(5)
    v_mfma_f32_32x32x16_bf16 v[36:51], v[68:71], v[52:55], v[36:51]
    ds_read_b64_tr_b16 v[80:81], v107 offset:24576
    ds_read_b64_tr_b16 v[82:83], v107 offset:25088
    s_waitcnt lgkmcnt(0)
    s_barrier
    ds_read_b128 v[52:55], v100 offset:32768
    ds_read_b64_tr_b16 v[60:61], v104 offset:40960
    ds_read_b64_tr_b16 v[62:63], v104 offset:41472
    ds_read_b64_tr_b16 v[64:65], v104 offset:49152
    ds_read_b64_tr_b16 v[66:67], v104 offset:49664
    ds_read_b64_tr_b16 v[68:69], v104 offset:57344
    ds_read_b64_tr_b16 v[70:71], v104 offset:57856
    v_mfma_f32_32x32x16_bf16 v[4:19], v[72:75], v[56:59], v[4:19]
    v_mfma_f32_32x32x16_bf16 v[20:35], v[76:79], v[56:59], v[20:35]
    v_mfma_f32_32x32x16_bf16 v[36:51], v[80:83], v[56:59], v[36:51]
    s_waitcnt lgkmcnt(4)
    v_mfma_f32_32x32x16_bf16 v[4:19], v[60:63], v[52:55], v[4:19]
    ds_read_b128 v[56:59], v101 offset:32768
    ds_read_b64_tr_b16 v[72:73], v105 offset:40960
    ds_read_b64_tr_b16 v[74:75], v105 offset:41472
    v_mfma_f32_16x16x32_bf16 v[84:87], v[60:63], v[96:99], v[84:87]
    s_waitcnt lgkmcnt(5)
    v_mfma_f32_32x32x16_bf16 v[20:35], v[64:67], v[52:55], v[20:35]
    ds_read_b64_tr_b16 v[76:77], v105 offset:49152
    ds_read_b64_tr_b16 v[78:79], v105 offset:49664
    v_mfma_f32_16x16x32_bf16 v[88:91], v[64:67], v[96:99], v[88:91]
    s_waitcnt lgkmcnt(5)
    v_mfma_f32_32x32x16_bf16 v[36:51], v[68:71], v[52:55], v[36:51]
    ds_read_b64_tr_b16 v[80:81], v105 offset:57344
    ds_read_b64_tr_b16 v[82:83], v105 offset:57856
    v_mfma_f32_16x16x32_bf16 v[92:95], v[68:71], v[96:99], v[92:95]
    s_waitcnt lgkmcnt(4)
    v_mfma_f32_32x32x16_bf16 v[4:19], v[72:75], v[56:59], v[4:19]
    ds_read_b128 v[52:55], v102 offset:32768
    ds_read_b64_tr_b16 v[60:61], v106 offset:40960
    ds_read_b64_tr_b16 v[62:63], v106 offset:41472
    v_mfma_f32_16x16x32_bf16 v[84:87], v[72:75], v[96:99], v[84:87]
    s_waitcnt lgkmcnt(5)
    v_mfma_f32_32x32x16_bf16 v[20:35], v[76:79], v[56:59], v[20:35]
    ds_read_b64_tr_b16 v[64:65], v106 offset:49152
    ds_read_b64_tr_b16 v[66:67], v106 offset:49664
    v_mfma_f32_16x16x32_bf16 v[88:91], v[76:79], v[96:99], v[88:91]
    s_waitcnt lgkmcnt(5)
    v_mfma_f32_32x32x16_bf16 v[36:51], v[80:83], v[56:59], v[36:51]
    ds_read_b64_tr_b16 v[68:69], v106 offset:57344
    ds_read_b64_tr_b16 v[70:71], v106 offset:57856
    v_mfma_f32_16x16x32_bf16 v[92:95], v[80:83], v[96:99], v[92:95]
    s_waitcnt lgkmcnt(4)
    v_mfma_f32_32x32x16_bf16 v[4:19], v[60:63], v[52:55], v[4:19]
    ds_read_b128 v[56:59], v103 offset:32768
    ds_read_b64_tr_b16 v[72:73], v107 offset:40960
    ds_read_b64_tr_b16 v[74:75], v107 offset:41472
    s_waitcnt lgkmcnt(5)
    v_mfma_f32_32x32x16_bf16 v[20:35], v[64:67], v[52:55], v[20:35]
    ds_read_b64_tr_b16 v[76:77], v107 offset:49152
    ds_read_b64_tr_b16 v[78:79], v107 offset:49664
    s_waitcnt lgkmcnt(5)
    v_mfma_f32_32x32x16_bf16 v[36:51], v[68:71], v[52:55], v[36:51]
    ds_read_b64_tr_b16 v[80:81], v107 offset:57344
    ds_read_b64_tr_b16 v[82:83], v107 offset:57856
    s_waitcnt lgkmcnt(0)
    s_barrier
    v_add_u32 v100, 0xffff0000, v100
    v_add_u32 v101, 0xffff0000, v101
    v_add_u32 v102, 0xffff0000, v102
    v_add_u32 v103, 0xffff0000, v103
    v_add_u32 v104, 0xffff0000, v104
    v_add_u32 v105, 0xffff0000, v105
    v_add_u32 v106, 0xffff0000, v106
    v_add_u32 v107, 0xffff0000, v107
    ds_read_b128 v[52:55], v100 offset:0
    ds_read_b64_tr_b16 v[60:61], v104 offset:8192
    ds_read_b64_tr_b16 v[62:63], v104 offset:8704
    ds_read_b64_tr_b16 v[64:65], v104 offset:16384
    ds_read_b64_tr_b16 v[66:67], v104 offset:16896
    ds_read_b64_tr_b16 v[68:69], v104 offset:24576
    ds_read_b64_tr_b16 v[70:71], v104 offset:25088
    v_mfma_f32_32x32x16_bf16 v[4:19], v[72:75], v[56:59], v[4:19]
    v_mfma_f32_32x32x16_bf16 v[20:35], v[76:79], v[56:59], v[20:35]
    v_mfma_f32_32x32x16_bf16 v[36:51], v[80:83], v[56:59], v[36:51]
    s_waitcnt lgkmcnt(4)
    v_mfma_f32_32x32x16_bf16 v[4:19], v[60:63], v[52:55], v[4:19]
    ds_read_b128 v[56:59], v101 offset:0
    ds_read_b64_tr_b16 v[72:73], v105 offset:8192
    ds_read_b64_tr_b16 v[74:75], v105 offset:8704
    v_mfma_f32_16x16x32_bf16 v[84:87], v[60:63], v[96:99], v[84:87]
    s_waitcnt lgkmcnt(5)
    v_mfma_f32_32x32x16_bf16 v[20:35], v[64:67], v[52:55], v[20:35]
    ds_read_b64_tr_b16 v[76:77], v105 offset:16384
    ds_read_b64_tr_b16 v[78:79], v105 offset:16896
    v_mfma_f32_16x16x32_bf16 v[88:91], v[64:67], v[96:99], v[88:91]
    s_waitcnt lgkmcnt(5)
    v_mfma_f32_32x32x16_bf16 v[36:51], v[68:71], v[52:55], v[36:51]
    ds_read_b64_tr_b16 v[80:81], v105 offset:24576
    ds_read_b64_tr_b16 v[82:83], v105 offset:25088
    v_mfma_f32_16x16x32_bf16 v[92:95], v[68:71], v[96:99], v[92:95]
    s_waitcnt lgkmcnt(4)
    v_mfma_f32_32x32x16_bf16 v[4:19], v[72:75], v[56:59], v[4:19]
    ds_read_b128 v[52:55], v102 offset:0
    ds_read_b64_tr_b16 v[60:61], v106 offset:8192
    ds_read_b64_tr_b16 v[62:63], v106 offset:8704
    v_mfma_f32_16x16x32_bf16 v[84:87], v[72:75], v[96:99], v[84:87]
    s_waitcnt lgkmcnt(5)
    v_mfma_f32_32x32x16_bf16 v[20:35], v[76:79], v[56:59], v[20:35]
    ds_read_b64_tr_b16 v[64:65], v106 offset:16384
    ds_read_b64_tr_b16 v[66:67], v106 offset:16896
    v_mfma_f32_16x16x32_bf16 v[88:91], v[76:79], v[96:99], v[88:91]
    s_waitcnt lgkmcnt(5)
    v_mfma_f32_32x32x16_bf16 v[36:51], v[80:83], v[56:59], v[36:51]
    ds_read_b64_tr_b16 v[68:69], v106 offset:24576
    ds_read_b64_tr_b16 v[70:71], v106 offset:25088
    v_mfma_f32_16x16x32_bf16 v[92:95], v[80:83], v[96:99], v[92:95]
    s_waitcnt lgkmcnt(4)
    v_mfma_f32_32x32x16_bf16 v[4:19], v[60:63], v[52:55], v[4:19]
    ds_read_b128 v[56:59], v103 offset:0
    ds_read_b64_tr_b16 v[72:73], v107 offset:8192
    ds_read_b64_tr_b16 v[74:75], v107 offset:8704
    s_waitcnt lgkmcnt(5)
    v_mfma_f32_32x32x16_bf16 v[20:35], v[64:67], v[52:55], v[20:35]
    ds_read_b64_tr_b16 v[76:77], v107 offset:16384
    ds_read_b64_tr_b16 v[78:79], v107 offset:16896
    s_waitcnt lgkmcnt(5)
    v_mfma_f32_32x32x16_bf16 v[36:51], v[68:71], v[52:55], v[36:51]
    ds_read_b64_tr_b16 v[80:81], v107 offset:24576
    ds_read_b64_tr_b16 v[82:83], v107 offset:25088
    s_waitcnt lgkmcnt(0)
    s_barrier
    ds_read_b128 v[52:55], v100 offset:32768
    ds_read_b64_tr_b16 v[60:61], v104 offset:40960
    ds_read_b64_tr_b16 v[62:63], v104 offset:41472
    ds_read_b64_tr_b16 v[64:65], v104 offset:49152
    ds_read_b64_tr_b16 v[66:67], v104 offset:49664
    ds_read_b64_tr_b16 v[68:69], v104 offset:57344
    ds_read_b64_tr_b16 v[70:71], v104 offset:57856
    v_mfma_f32_32x32x16_bf16 v[4:19], v[72:75], v[56:59], v[4:19]
    v_mfma_f32_32x32x16_bf16 v[20:35], v[76:79], v[56:59], v[20:35]
    v_mfma_f32_32x32x16_bf16 v[36:51], v[80:83], v[56:59], v[36:51]
    s_waitcnt lgkmcnt(4)
    v_mfma_f32_32x32x16_bf16 v[4:19], v[60:63], v[52:55], v[4:19]
    ds_read_b128 v[56:59], v101 offset:32768
    ds_read_b64_tr_b16 v[72:73], v105 offset:40960
    ds_read_b64_tr_b16 v[74:75], v105 offset:41472
    v_mfma_f32_16x16x32_bf16 v[84:87], v[60:63], v[96:99], v[84:87]
    s_waitcnt lgkmcnt(5)
    v_mfma_f32_32x32x16_bf16 v[20:35], v[64:67], v[52:55], v[20:35]
    ds_read_b64_tr_b16 v[76:77], v105 offset:49152
    ds_read_b64_tr_b16 v[78:79], v105 offset:49664
    v_mfma_f32_16x16x32_bf16 v[88:91], v[64:67], v[96:99], v[88:91]
    s_waitcnt lgkmcnt(5)
    v_mfma_f32_32x32x16_bf16 v[36:51], v[68:71], v[52:55], v[36:51]
    ds_read_b64_tr_b16 v[80:81], v105 offset:57344
    ds_read_b64_tr_b16 v[82:83], v105 offset:57856
    v_mfma_f32_16x16x32_bf16 v[92:95], v[68:71], v[96:99], v[92:95]
    s_waitcnt lgkmcnt(4)
    v_mfma_f32_32x32x16_bf16 v[4:19], v[72:75], v[56:59], v[4:19]
    ds_read_b128 v[52:55], v102 offset:32768
    ds_read_b64_tr_b16 v[60:61], v106 offset:40960
    ds_read_b64_tr_b16 v[62:63], v106 offset:41472
    v_mfma_f32_16x16x32_bf16 v[84:87], v[72:75], v[96:99], v[84:87]
    s_waitcnt lgkmcnt(5)
    v_mfma_f32_32x32x16_bf16 v[20:35], v[76:79], v[56:59], v[20:35]
    ds_read_b64_tr_b16 v[64:65], v106 offset:49152
    ds_read_b64_tr_b16 v[66:67], v106 offset:49664
    v_mfma_f32_16x16x32_bf16 v[88:91], v[76:79], v[96:99], v[88:91]
    s_waitcnt lgkmcnt(5)
    v_mfma_f32_32x32x16_bf16 v[36:51], v[80:83], v[56:59], v[36:51]
    ds_read_b64_tr_b16 v[68:69], v106 offset:57344
    ds_read_b64_tr_b16 v[70:71], v106 offset:57856
    v_mfma_f32_16x16x32_bf16 v[92:95], v[80:83], v[96:99], v[92:95]
    s_waitcnt lgkmcnt(4)
    v_mfma_f32_32x32x16_bf16 v[4:19], v[60:63], v[52:55], v[4:19]
    ds_read_b128 v[56:59], v103 offset:32768
    ds_read_b64_tr_b16 v[72:73], v107 offset:40960
    ds_read_b64_tr_b16 v[74:75], v107 offset:41472
    s_waitcnt lgkmcnt(5)
    v_mfma_f32_32x32x16_bf16 v[20:35], v[64:67], v[52:55], v[20:35]
    ds_read_b64_tr_b16 v[76:77], v107 offset:49152
    ds_read_b64_tr_b16 v[78:79], v107 offset:49664
    s_waitcnt lgkmcnt(5)
    v_mfma_f32_32x32x16_bf16 v[36:51], v[68:71], v[52:55], v[36:51]
    ds_read_b64_tr_b16 v[80:81], v107 offset:57344
    ds_read_b64_tr_b16 v[82:83], v107 offset:57856
    s_waitcnt lgkmcnt(0)
    s_barrier
    v_add_u32 v100, 0x10000, v100
    v_add_u32 v101, 0x10000, v101
    v_add_u32 v102, 0x10000, v102
    v_add_u32 v103, 0x10000, v103
    v_add_u32 v104, 0x10000, v104
    v_add_u32 v105, 0x10000, v105
    v_add_u32 v106, 0x10000, v106
    v_add_u32 v107, 0x10000, v107
    ds_read_b128 v[52:55], v100 offset:0
    ds_read_b64_tr_b16 v[60:61], v104 offset:8192
    ds_read_b64_tr_b16 v[62:63], v104 offset:8704
    ds_read_b64_tr_b16 v[64:65], v104 offset:16384
    ds_read_b64_tr_b16 v[66:67], v104 offset:16896
    ds_read_b64_tr_b16 v[68:69], v104 offset:24576
    ds_read_b64_tr_b16 v[70:71], v104 offset:25088
    v_mfma_f32_32x32x16_bf16 v[4:19], v[72:75], v[56:59], v[4:19]
    v_mfma_f32_32x32x16_bf16 v[20:35], v[76:79], v[56:59], v[20:35]
    v_mfma_f32_32x32x16_bf16 v[36:51], v[80:83], v[56:59], v[36:51]
    s_waitcnt lgkmcnt(4)
    v_mfma_f32_32x32x16_bf16 v[4:19], v[60:63], v[52:55], v[4:19]
    ds_read_b128 v[56:59], v101 offset:0
    ds_read_b64_tr_b16 v[72:73], v105 offset:8192
    ds_read_b64_tr_b16 v[74:75], v105 offset:8704
    v_mfma_f32_16x16x32_bf16 v[84:87], v[60:63], v[96:99], v[84:87]
    s_waitcnt lgkmcnt(5)
    v_mfma_f32_32x32x16_bf16 v[20:35], v[64:67], v[52:55], v[20:35]
    ds_read_b64_tr_b16 v[76:77], v105 offset:16384
    ds_read_b64_tr_b16 v[78:79], v105 offset:16896
    v_mfma_f32_16x16x32_bf16 v[88:91], v[64:67], v[96:99], v[88:91]
    s_waitcnt lgkmcnt(5)
    v_mfma_f32_32x32x16_bf16 v[36:51], v[68:71], v[52:55], v[36:51]
    ds_read_b64_tr_b16 v[80:81], v105 offset:24576
    ds_read_b64_tr_b16 v[82:83], v105 offset:25088
    v_mfma_f32_16x16x32_bf16 v[92:95], v[68:71], v[96:99], v[92:95]
    s_waitcnt lgkmcnt(4)
    v_mfma_f32_32x32x16_bf16 v[4:19], v[72:75], v[56:59], v[4:19]
    ds_read_b128 v[52:55], v102 offset:0
    ds_read_b64_tr_b16 v[60:61], v106 offset:8192
    ds_read_b64_tr_b16 v[62:63], v106 offset:8704
    v_mfma_f32_16x16x32_bf16 v[84:87], v[72:75], v[96:99], v[84:87]
    s_waitcnt lgkmcnt(5)
    v_mfma_f32_32x32x16_bf16 v[20:35], v[76:79], v[56:59], v[20:35]
    ds_read_b64_tr_b16 v[64:65], v106 offset:16384
    ds_read_b64_tr_b16 v[66:67], v106 offset:16896
    v_mfma_f32_16x16x32_bf16 v[88:91], v[76:79], v[96:99], v[88:91]
    s_waitcnt lgkmcnt(5)
    v_mfma_f32_32x32x16_bf16 v[36:51], v[80:83], v[56:59], v[36:51]
    ds_read_b64_tr_b16 v[68:69], v106 offset:24576
    ds_read_b64_tr_b16 v[70:71], v106 offset:25088
    v_mfma_f32_16x16x32_bf16 v[92:95], v[80:83], v[96:99], v[92:95]
    s_waitcnt lgkmcnt(4)
    v_mfma_f32_32x32x16_bf16 v[4:19], v[60:63], v[52:55], v[4:19]
    ds_read_b128 v[56:59], v103 offset:0
    ds_read_b64_tr_b16 v[72:73], v107 offset:8192
    ds_read_b64_tr_b16 v[74:75], v107 offset:8704
    s_waitcnt lgkmcnt(5)
    v_mfma_f32_32x32x16_bf16 v[20:35], v[64:67], v[52:55], v[20:35]
    ds_read_b64_tr_b16 v[76:77], v107 offset:16384
    ds_read_b64_tr_b16 v[78:79], v107 offset:16896
    s_waitcnt lgkmcnt(5)
    v_mfma_f32_32x32x16_bf16 v[36:51], v[68:71], v[52:55], v[36:51]
    ds_read_b64_tr_b16 v[80:81], v107 offset:24576
    ds_read_b64_tr_b16 v[82:83], v107 offset:25088
    s_waitcnt lgkmcnt(0)
    s_barrier
    ds_read_b128 v[52:55], v100 offset:32768
    ds_read_b64_tr_b16 v[60:61], v104 offset:40960
    ds_read_b64_tr_b16 v[62:63], v104 offset:41472
    ds_read_b64_tr_b16 v[64:65], v104 offset:49152
    ds_read_b64_tr_b16 v[66:67], v104 offset:49664
    ds_read_b64_tr_b16 v[68:69], v104 offset:57344
    ds_read_b64_tr_b16 v[70:71], v104 offset:57856
    v_mfma_f32_32x32x16_bf16 v[4:19], v[72:75], v[56:59], v[4:19]
    v_mfma_f32_32x32x16_bf16 v[20:35], v[76:79], v[56:59], v[20:35]
    v_mfma_f32_32x32x16_bf16 v[36:51], v[80:83], v[56:59], v[36:51]
    s_waitcnt lgkmcnt(4)
    v_mfma_f32_32x32x16_bf16 v[4:19], v[60:63], v[52:55], v[4:19]
    ds_read_b128 v[56:59], v101 offset:32768
    ds_read_b64_tr_b16 v[72:73], v105 offset:40960
    ds_read_b64_tr_b16 v[74:75], v105 offset:41472
    v_mfma_f32_16x16x32_bf16 v[84:87], v[60:63], v[96:99], v[84:87]
    s_waitcnt lgkmcnt(5)
    v_mfma_f32_32x32x16_bf16 v[20:35], v[64:67], v[52:55], v[20:35]
    ds_read_b64_tr_b16 v[76:77], v105 offset:49152
    ds_read_b64_tr_b16 v[78:79], v105 offset:49664
    v_mfma_f32_16x16x32_bf16 v[88:91], v[64:67], v[96:99], v[88:91]
    s_waitcnt lgkmcnt(5)
    v_mfma_f32_32x32x16_bf16 v[36:51], v[68:71], v[52:55], v[36:51]
    ds_read_b64_tr_b16 v[80:81], v105 offset:57344
    ds_read_b64_tr_b16 v[82:83], v105 offset:57856
    v_mfma_f32_16x16x32_bf16 v[92:95], v[68:71], v[96:99], v[92:95]
    s_waitcnt lgkmcnt(4)
    v_mfma_f32_32x32x16_bf16 v[4:19], v[72:75], v[56:59], v[4:19]
    ds_read_b128 v[52:55], v102 offset:32768
    ds_read_b64_tr_b16 v[60:61], v106 offset:40960
    ds_read_b64_tr_b16 v[62:63], v106 offset:41472
    v_mfma_f32_16x16x32_bf16 v[84:87], v[72:75], v[96:99], v[84:87]
    s_waitcnt lgkmcnt(5)
    v_mfma_f32_32x32x16_bf16 v[20:35], v[76:79], v[56:59], v[20:35]
    ds_read_b64_tr_b16 v[64:65], v106 offset:49152
    ds_read_b64_tr_b16 v[66:67], v106 offset:49664
    v_mfma_f32_16x16x32_bf16 v[88:91], v[76:79], v[96:99], v[88:91]
    s_waitcnt lgkmcnt(5)
    v_mfma_f32_32x32x16_bf16 v[36:51], v[80:83], v[56:59], v[36:51]
    ds_read_b64_tr_b16 v[68:69], v106 offset:57344
    ds_read_b64_tr_b16 v[70:71], v106 offset:57856
    v_mfma_f32_16x16x32_bf16 v[92:95], v[80:83], v[96:99], v[92:95]
    s_waitcnt lgkmcnt(4)
    v_mfma_f32_32x32x16_bf16 v[4:19], v[60:63], v[52:55], v[4:19]
    ds_read_b128 v[56:59], v103 offset:32768
    ds_read_b64_tr_b16 v[72:73], v107 offset:40960
    ds_read_b64_tr_b16 v[74:75], v107 offset:41472
    s_waitcnt lgkmcnt(5)
    v_mfma_f32_32x32x16_bf16 v[20:35], v[64:67], v[52:55], v[20:35]
    ds_read_b64_tr_b16 v[76:77], v107 offset:49152
    ds_read_b64_tr_b16 v[78:79], v107 offset:49664
    s_waitcnt lgkmcnt(5)
    v_mfma_f32_32x32x16_bf16 v[36:51], v[68:71], v[52:55], v[36:51]
    ds_read_b64_tr_b16 v[80:81], v107 offset:57344
    ds_read_b64_tr_b16 v[82:83], v107 offset:57856
    s_waitcnt lgkmcnt(0)
    v_mfma_f32_32x32x16_bf16 v[4:19], v[72:75], v[56:59], v[4:19]
    v_mfma_f32_32x32x16_bf16 v[20:35], v[76:79], v[56:59], v[20:35]
    v_mfma_f32_32x32x16_bf16 v[36:51], v[80:83], v[56:59], v[36:51]
    v_and_b32 v111, 1, v0
    v_lshlrev_b32 v111, 6, v111
    v_lshrrev_b32 v112, 4, v0
    v_lshl_add_u32 v111, v112, 4, v111
    s_mul_i32 s40, s3, 384
    s_add_u32 s40, s40, 66048
    v_add_u32 v111, s40, v111
    s_mov_b32 s40, 0x00030003
    s_mov_b32 s41, 0x00030003
    s_mov_b64 exec, s[40:41]
    ds_write_b128 v111, v[84:87] offset:0
    ds_write_b128 v111, v[88:91] offset:128
    ds_write_b128 v111, v[92:95] offset:256
    s_mov_b64 exec, -1
    v_and_b32 v109, 31, v0
    v_lshrrev_b32 v110, 5, v0
    v_lshlrev_b32 v120, 4, v0
    s_lshl_b32 s40, s47, 12
    s_lshl_b32 s41, s46, 10
    s_add_u32 s40, s40, s41
    s_add_u32 s40, s40, 90112
    v_add_u32 v117, s40, v120
    s_lshl_b32 s40, s3, 12
    s_add_u32 s40, s40, 69632
    v_lshlrev_b32 v111, 5, v109
    v_lshl_add_u32 v111, v110, 4, v111
    v_add_u32 v118, s40, v111
    v_add_u32 v119, s40, v120
    s_mul_i32 s40, s47, 768
    s_add_u32 s40, s40, 66048
    v_lshl_add_u32 v121, v109, 2, s40
    s_lshl_b32 s40, s46, 8
    s_add_u32 s40, s40, 65536
    v_lshl_add_u32 v122, v109, 3, s40
    s_add_u32 s28, s22, 0x100000
    s_addc_u32 s29, s23, 0
    s_mov_b32 s30, 0x400000
    s_mov_b32 s31, 0x20000
    s_lshl_b32 s42, s99, 2
    s_lshl_b32 s41, s47, 1
    s_add_u32 s42, s42, s41
    s_lshl_b32 s42, s42, 16
    s_lshl_b32 s41, s98, 11
    s_add_u32 s42, s42, s41
    s_lshl_b32 s41, s46, 10
    s_add_u32 s42, s42, s41
    s_add_u32 s43, s42, 65536
    s_add_u32 s48, s42, 0x200000
    s_add_u32 s49, s42, 0x210000
    s_mov_b32 s62, -1
    s_mov_b32 s63, 0
    s_waitcnt lgkmcnt(0)
    s_barrier
    ds_read_b64 v[124:125], v122
    ds_read_b32 v128, v121 offset:0
    ds_read_b32 v129, v121 offset:384
    ds_read_b32 v130, v121 offset:128
    ds_read_b32 v131, v121 offset:512
    ds_read_b32 v132, v121 offset:256
    ds_read_b32 v133, v121 offset:640
    v_mov_b32 v114, 67584
    ds_read_b64 v[126:127], v114
    s_waitcnt lgkmcnt(0)
    v_readfirstlane_b32 s27, v127
    v_add_f32 v128, v128, v129
    v_add_f32 v130, v130, v131
    v_add_f32 v132, v132, v133
    v_mov_b32 v134, v125
    v_mul_f32 v136, 0x3eb8aa3b, v125
    s_and_b32 s100, s100, s27
    v_cvt_pk_bf16_f32 v109, v124, v124
    v_lshlrev_b32 v109, 16, v109
    v_sub_f32_e64 v110, v124, v109
    v_cvt_pk_bf16_f32 v72, v109, v109
    v_cvt_pk_bf16_f32 v73, v110, 0
    v_mov_b32 v74, 0
    v_mov_b32 v75, 0
    v_cndmask_b32_e64 v128, 0, v128, s[62:63]
    v_cvt_pk_bf16_f32 v111, v128, v128
    v_lshlrev_b32 v111, 16, v111
    v_sub_f32 v112, v128, v111
    v_cvt_pk_bf16_f32 v60, v111, v112
    v_cvt_pk_bf16_f32 v61, v111, 0
    v_mov_b32 v62, 0
    v_mov_b32_e64 v63, 0
    s_nop 1
    v_mfma_f32_32x32x16_bf16 v[4:19], v[60:63], v[72:75], v[4:19]
    v_cndmask_b32_e64 v130, 0, v130, s[62:63]
    v_cvt_pk_bf16_f32 v111, v130, v130
    v_lshlrev_b32 v111, 16, v111
    v_sub_f32 v112, v130, v111
    v_cvt_pk_bf16_f32 v64, v111, v112
    v_cvt_pk_bf16_f32 v65, v111, 0
    v_mov_b32 v66, 0
    v_mov_b32_e64 v67, 0
    s_nop 1
    v_mfma_f32_32x32x16_bf16 v[20:35], v[64:67], v[72:75], v[20:35]
    v_cndmask_b32_e64 v132, 0, v132, s[62:63]
    v_cvt_pk_bf16_f32 v111, v132, v132
    v_lshlrev_b32 v111, 16, v111
    v_sub_f32 v112, v132, v111
    v_cvt_pk_bf16_f32 v68, v111, v112
    v_cvt_pk_bf16_f32 v69, v111, 0
    v_mov_b32 v70, 0
    v_mov_b32_e64 v71, 0
    s_nop 1
    v_mfma_f32_32x32x16_bf16 v[36:51], v[68:71], v[72:75], v[36:51]
    s_nop 0
    v_pk_mul_f32 v[20:21], v[20:21], v[134:135] op_sel_hi:[1,0]
    v_pk_mul_f32 v[22:23], v[22:23], v[134:135] op_sel_hi:[1,0]
    v_pk_mul_f32 v[24:25], v[24:25], v[134:135] op_sel_hi:[1,0]
    v_pk_mul_f32 v[26:27], v[26:27], v[134:135] op_sel_hi:[1,0]
    v_pk_mul_f32 v[28:29], v[28:29], v[134:135] op_sel_hi:[1,0]
    v_pk_mul_f32 v[30:31], v[30:31], v[134:135] op_sel_hi:[1,0]
    v_pk_mul_f32 v[32:33], v[32:33], v[134:135] op_sel_hi:[1,0]
    v_pk_mul_f32 v[34:35], v[34:35], v[134:135] op_sel_hi:[1,0]
    v_cvt_pk_bf16_f32 v76, v20, v21
    v_cvt_pk_bf16_f32 v77, v22, v23
    v_cvt_pk_bf16_f32 v78, v24, v25
    v_cvt_pk_bf16_f32 v79, v26, v27
    v_cvt_pk_bf16_f32 v80, v28, v29
    v_cvt_pk_bf16_f32 v81, v30, v31
    v_cvt_pk_bf16_f32 v82, v32, v33
    v_cvt_pk_bf16_f32 v83, v34, v35
    ds_write_b128 v118, v[76:79] offset:0
    ds_write_b128 v118, v[80:83] offset:1024
    v_pk_mul_f32 v[36:37], v[36:37], v[134:135] op_sel_hi:[1,0]
    v_pk_mul_f32 v[38:39], v[38:39], v[134:135] op_sel_hi:[1,0]
    v_pk_mul_f32 v[40:41], v[40:41], v[134:135] op_sel_hi:[1,0]
    v_pk_mul_f32 v[42:43], v[42:43], v[134:135] op_sel_hi:[1,0]
    v_pk_mul_f32 v[44:45], v[44:45], v[134:135] op_sel_hi:[1,0]
    v_pk_mul_f32 v[46:47], v[46:47], v[134:135] op_sel_hi:[1,0]
    v_pk_mul_f32 v[48:49], v[48:49], v[134:135] op_sel_hi:[1,0]
    v_pk_mul_f32 v[50:51], v[50:51], v[134:135] op_sel_hi:[1,0]
    v_cvt_pk_bf16_f32 v140, v36, v37
    v_cvt_pk_bf16_f32 v141, v38, v39
    v_cvt_pk_bf16_f32 v142, v40, v41
    v_cvt_pk_bf16_f32 v143, v42, v43
    v_cvt_pk_bf16_f32 v144, v44, v45
    v_cvt_pk_bf16_f32 v145, v46, v47
    v_cvt_pk_bf16_f32 v146, v48, v49
    v_cvt_pk_bf16_f32 v147, v50, v51
    ds_write_b128 v118, v[140:143] offset:2048
    ds_write_b128 v118, v[144:147] offset:3072
    s_waitcnt lgkmcnt(0)
    ds_read_b128 v[148:151], v119 offset:0
    ds_read_b128 v[152:155], v119 offset:1024
    ds_read_b128 v[156:159], v119 offset:2048
    ds_read_b128 v[160:163], v119 offset:3072
    v_pk_mul_f32 v[4:5], v[4:5], v[136:137] op_sel_hi:[1,0]
    v_pk_mul_f32 v[6:7], v[6:7], v[136:137] op_sel_hi:[1,0]
    v_pk_mul_f32 v[8:9], v[8:9], v[136:137] op_sel_hi:[1,0]
    v_pk_mul_f32 v[10:11], v[10:11], v[136:137] op_sel_hi:[1,0]
    v_pk_mul_f32 v[12:13], v[12:13], v[136:137] op_sel_hi:[1,0]
    v_pk_mul_f32 v[14:15], v[14:15], v[136:137] op_sel_hi:[1,0]
    v_pk_mul_f32 v[16:17], v[16:17], v[136:137] op_sel_hi:[1,0]
    v_pk_mul_f32 v[18:19], v[18:19], v[136:137] op_sel_hi:[1,0]
    s_waitcnt lgkmcnt(0)
    s_cmp_eq_u32 s100, 0
    s_cbranch_scc1 tw_10
    buffer_store_dwordx4 v[148:151], v120, s[28:31], s42 offen
    buffer_store_dwordx4 v[152:155], v120, s[28:31], s43 offen
    buffer_store_dwordx4 v[156:159], v120, s[28:31], s48 offen
    buffer_store_dwordx4 v[160:163], v120, s[28:31], s49 offen
tw_10_e:
    v_cvt_pk_bf16_f32 v52, v4, v5
    v_cvt_pk_bf16_f32 v53, v6, v7
    v_cvt_pk_bf16_f32 v54, v8, v9
    v_cvt_pk_bf16_f32 v55, v10, v11
    v_cvt_pk_bf16_f32 v56, v12, v13
    v_cvt_pk_bf16_f32 v57, v14, v15
    v_cvt_pk_bf16_f32 v58, v16, v17
    v_cvt_pk_bf16_f32 v59, v18, v19
    ds_write_b128 v117, v[52:55]
    ds_write_b128 v117, v[56:59] offset:2048
    s_waitcnt vmcnt(0) lgkmcnt(0)
    s_barrier
    s_branch C_p2
C_p1_aux:
    s_getpc_b64 s[52:53]
pc_here:
    s_sub_u32 s52, s52, pc_here-sequential_preLN__sliding_block__geglu_ffn__prompt_kernel
    s_subb_u32 s53, s53, 0
    s_sub_u32 s54, s3, 4
    s_lshl_b32 s55, s25, 2
    s_add_u32 s55, s55, s54
    s_lshl_b32 s55, s55, 9
    v_lshlrev_b32 v14, 7, v0
    v_add_u32 v14, s55, v14
    s_mov_b32 s55, sequential_preLN__sliding_block__geglu_ffn__prompt_kernel_end-sequential_preLN__sliding_block__geglu_ffn__prompt_kernel
    v_cmp_gt_u32 vcc, s55, v14
    s_mov_b64 s[40:41], exec
    s_and_b64 exec, vcc, 15
    s_cbranch_execz C_cp_skip
    global_load_dword v15, v14, s[52:53]
C_cp_skip:
    s_mov_b64 exec, s[40:41]
    s_cmp_eq_u32 s3, 4
    s_cbranch_scc0 C_aux_go
    s_cmp_eq_u32 s2, 0
    s_cbranch_scc0 C_aux_go
    s_memrealtime s[58:59]
    v_mov_b32 v20, 0
    s_waitcnt lgkmcnt(0)
    s_or_b32 s58, s58, 1
    v_mov_b32 v19, s58
    s_mov_b64 s[40:41], exec
    s_mov_b64 exec, 1
    global_store_dword v20, v19, s[20:21] sc1
    s_mov_b64 exec, s[40:41]
C_aux_go:
    v_lshrrev_b32 v30, 2, v0
    s_lshl_b32 s55, s54, 4
    v_add_u32 v30, s55, v30
    v_and_b32 v31, 3, v0
    v_lshlrev_b32_e64 v32, 7, v30
    v_lshl_add_u32 v32, v31, 5, v32
    v_mov_b32 v40, 0
    v_mov_b32 v41, 0
    v_mov_b32 v42, 0
    v_mov_b32 v43, 0
    s_barrier
    ds_read_b128 v[44:47], v32 offset:0
    ds_read_b128 v[48:51], v32 offset:16
    s_waitcnt lgkmcnt(0)
    v_lshlrev_b32_e64 v52, 16, v44
    v_and_b32 v53, 0xffff0000, v44
    v_add_f32 v40, v40, v52
    v_fmac_f32 v42, v52, v52
    v_add_f32 v41, v41, v53
    v_fmac_f32 v43, v53, v53
    v_lshlrev_b32_e64 v52, 16, v45
    v_and_b32 v53, 0xffff0000, v45
    v_add_f32 v40, v40, v52
    v_fmac_f32 v42, v52, v52
    v_add_f32 v41, v41, v53
    v_fmac_f32 v43, v53, v53
    v_lshlrev_b32_e64 v52, 16, v46
    v_and_b32 v53, 0xffff0000, v46
    v_add_f32 v40, v40, v52
    v_fmac_f32 v42, v52, v52
    v_add_f32 v41, v41, v53
    v_fmac_f32 v43, v53, v53
    v_lshlrev_b32_e64 v52, 16, v47
    v_and_b32 v53, 0xffff0000, v47
    v_add_f32 v40, v40, v52
    v_fmac_f32 v42, v52, v52
    v_add_f32 v41, v41, v53
    v_fmac_f32 v43, v53, v53
    v_lshlrev_b32_e64 v52, 16, v48
    v_and_b32 v53, 0xffff0000, v48
    v_add_f32 v40, v40, v52
    v_fmac_f32 v42, v52, v52
    v_add_f32 v41, v41, v53
    v_fmac_f32 v43, v53, v53
    v_lshlrev_b32_e64 v52, 16, v49
    v_and_b32 v53, 0xffff0000, v49
    v_add_f32 v40, v40, v52
    v_fmac_f32 v42, v52, v52
    v_add_f32 v41, v41, v53
    v_fmac_f32 v43, v53, v53
    v_lshlrev_b32_e64 v52, 16, v50
    v_and_b32 v53, 0xffff0000, v50
    v_add_f32 v40, v40, v52
    v_fmac_f32 v42, v52, v52
    v_add_f32 v41, v41, v53
    v_fmac_f32 v43, v53, v53
    v_lshlrev_b32_e64 v52, 16, v51
    v_and_b32 v53, 0xffff0000, v51
    v_add_f32 v40, v40, v52
    v_fmac_f32 v42, v52, v52
    v_add_f32 v41, v41, v53
    v_fmac_f32 v43, v53, v53
    s_barrier
    ds_read_b128 v[44:47], v32 offset:32768
    ds_read_b128 v[48:51], v32 offset:32784
    s_waitcnt lgkmcnt(0)
    v_lshlrev_b32_e64 v52, 16, v44
    v_and_b32 v53, 0xffff0000, v44
    v_add_f32 v40, v40, v52
    v_fmac_f32 v42, v52, v52
    v_add_f32 v41, v41, v53
    v_fmac_f32 v43, v53, v53
    v_lshlrev_b32_e64 v52, 16, v45
    v_and_b32 v53, 0xffff0000, v45
    v_add_f32 v40, v40, v52
    v_fmac_f32 v42, v52, v52
    v_add_f32 v41, v41, v53
    v_fmac_f32 v43, v53, v53
    v_lshlrev_b32_e64 v52, 16, v46
    v_and_b32 v53, 0xffff0000, v46
    v_add_f32 v40, v40, v52
    v_fmac_f32 v42, v52, v52
    v_add_f32 v41, v41, v53
    v_fmac_f32 v43, v53, v53
    v_lshlrev_b32_e64 v52, 16, v47
    v_and_b32 v53, 0xffff0000, v47
    v_add_f32 v40, v40, v52
    v_fmac_f32 v42, v52, v52
    v_add_f32 v41, v41, v53
    v_fmac_f32 v43, v53, v53
    v_lshlrev_b32_e64 v52, 16, v48
    v_and_b32 v53, 0xffff0000, v48
    v_add_f32 v40, v40, v52
    v_fmac_f32 v42, v52, v52
    v_add_f32 v41, v41, v53
    v_fmac_f32 v43, v53, v53
    v_lshlrev_b32_e64 v52, 16, v49
    v_and_b32 v53, 0xffff0000, v49
    v_add_f32 v40, v40, v52
    v_fmac_f32 v42, v52, v52
    v_add_f32 v41, v41, v53
    v_fmac_f32 v43, v53, v53
    v_lshlrev_b32_e64 v52, 16, v50
    v_and_b32 v53, 0xffff0000, v50
    v_add_f32 v40, v40, v52
    v_fmac_f32 v42, v52, v52
    v_add_f32 v41, v41, v53
    v_fmac_f32 v43, v53, v53
    v_lshlrev_b32_e64 v52, 16, v51
    v_and_b32 v53, 0xffff0000, v51
    v_add_f32 v40, v40, v52
    v_fmac_f32 v42, v52, v52
    v_add_f32 v41, v41, v53
    v_fmac_f32_e64 v43, v53, v53
    s_barrier
    v_add_u32 v32, 0x10000, v32
    ds_read_b128 v[44:47], v32 offset:0
    ds_read_b128 v[48:51], v32 offset:16
    s_waitcnt lgkmcnt(0)
    v_lshlrev_b32 v52, 16, v44
    v_and_b32 v53, 0xffff0000, v44
    v_add_f32 v40, v40, v52
    v_fmac_f32 v42, v52, v52
    v_add_f32 v41, v41, v53
    v_fmac_f32 v43, v53, v53
    v_lshlrev_b32_e64 v52, 16, v45
    v_and_b32 v53, 0xffff0000, v45
    v_add_f32 v40, v40, v52
    v_fmac_f32 v42, v52, v52
    v_add_f32 v41, v41, v53
    v_fmac_f32 v43, v53, v53
    v_lshlrev_b32_e64 v52, 16, v46
    v_and_b32 v53, 0xffff0000, v46
    v_add_f32 v40, v40, v52
    v_fmac_f32 v42, v52, v52
    v_add_f32 v41, v41, v53
    v_fmac_f32 v43, v53, v53
    v_lshlrev_b32_e64 v52, 16, v47
    v_and_b32 v53, 0xffff0000, v47
    v_add_f32 v40, v40, v52
    v_fmac_f32 v42, v52, v52
    v_add_f32 v41, v41, v53
    v_fmac_f32 v43, v53, v53
    v_lshlrev_b32_e64 v52, 16, v48
    v_and_b32 v53, 0xffff0000, v48
    v_add_f32 v40, v40, v52
    v_fmac_f32 v42, v52, v52
    v_add_f32 v41, v41, v53
    v_fmac_f32 v43, v53, v53
    v_lshlrev_b32_e64 v52, 16, v49
    v_and_b32 v53, 0xffff0000, v49
    v_add_f32 v40, v40, v52
    v_fmac_f32 v42, v52, v52
    v_add_f32 v41, v41, v53
    v_fmac_f32 v43, v53, v53
    v_lshlrev_b32_e64 v52, 16, v50
    v_and_b32 v53, 0xffff0000, v50
    v_add_f32 v40, v40, v52
    v_fmac_f32 v42, v52, v52
    v_add_f32 v41, v41, v53
    v_fmac_f32 v43, v53, v53
    v_lshlrev_b32_e64 v52, 16, v51
    v_and_b32 v53, 0xffff0000, v51
    v_add_f32 v40, v40, v52
    v_fmac_f32 v42, v52, v52
    v_add_f32 v41, v41, v53
    v_fmac_f32 v43, v53, v53
    s_barrier
    ds_read_b128 v[44:47], v32 offset:32768
    ds_read_b128 v[48:51], v32 offset:32784
    s_waitcnt lgkmcnt(0)
    v_lshlrev_b32_e64 v52, 16, v44
    v_and_b32 v53, 0xffff0000, v44
    v_add_f32 v40, v40, v52
    v_fmac_f32 v42, v52, v52
    v_add_f32 v41, v41, v53
    v_fmac_f32 v43, v53, v53
    v_lshlrev_b32_e64 v52, 16, v45
    v_and_b32 v53, 0xffff0000, v45
    v_add_f32 v40, v40, v52
    v_fmac_f32 v42, v52, v52
    v_add_f32 v41, v41, v53
    v_fmac_f32 v43, v53, v53
    v_lshlrev_b32_e64 v52, 16, v46
    v_and_b32 v53, 0xffff0000, v46
    v_add_f32 v40, v40, v52
    v_fmac_f32 v42, v52, v52
    v_add_f32 v41, v41, v53
    v_fmac_f32 v43, v53, v53
    v_lshlrev_b32_e64 v52, 16, v47
    v_and_b32 v53, 0xffff0000, v47
    v_add_f32 v40, v40, v52
    v_fmac_f32 v42, v52, v52
    v_add_f32 v41, v41, v53
    v_fmac_f32 v43, v53, v53
    v_lshlrev_b32_e64 v52, 16, v48
    v_and_b32 v53, 0xffff0000, v48
    v_add_f32 v40, v40, v52
    v_fmac_f32 v42, v52, v52
    v_add_f32 v41, v41, v53
    v_fmac_f32 v43, v53, v53
    v_lshlrev_b32_e64 v52, 16, v49
    v_and_b32 v53, 0xffff0000, v49
    v_add_f32 v40, v40, v52
    v_fmac_f32 v42, v52, v52
    v_add_f32 v41, v41, v53
    v_fmac_f32 v43, v53, v53
    v_lshlrev_b32_e64 v52, 16, v50
    v_and_b32 v53, 0xffff0000, v50
    v_add_f32 v40, v40, v52
    v_fmac_f32 v42, v52, v52
    v_add_f32 v41, v41, v53
    v_fmac_f32 v43, v53, v53
    v_lshlrev_b32_e64 v52, 16, v51
    v_and_b32 v53, 0xffff0000, v51
    v_add_f32 v40, v40, v52
    v_fmac_f32 v42, v52, v52
    v_add_f32 v41, v41, v53
    v_fmac_f32_e64 v43, v53, v53
    s_barrier
    v_add_u32 v32, 0xffff0000, v32
    ds_read_b128 v[44:47], v32 offset:0
    ds_read_b128 v[48:51], v32 offset:16
    s_waitcnt lgkmcnt(0)
    v_lshlrev_b32 v52, 16, v44
    v_and_b32 v53, 0xffff0000, v44
    v_add_f32 v40, v40, v52
    v_fmac_f32 v42, v52, v52
    v_add_f32 v41, v41, v53
    v_fmac_f32 v43, v53, v53
    v_lshlrev_b32_e64 v52, 16, v45
    v_and_b32 v53, 0xffff0000, v45
    v_add_f32 v40, v40, v52
    v_fmac_f32 v42, v52, v52
    v_add_f32 v41, v41, v53
    v_fmac_f32 v43, v53, v53
    v_lshlrev_b32_e64 v52, 16, v46
    v_and_b32 v53, 0xffff0000, v46
    v_add_f32 v40, v40, v52
    v_fmac_f32 v42, v52, v52
    v_add_f32 v41, v41, v53
    v_fmac_f32 v43, v53, v53
    v_lshlrev_b32_e64 v52, 16, v47
    v_and_b32 v53, 0xffff0000, v47
    v_add_f32 v40, v40, v52
    v_fmac_f32 v42, v52, v52
    v_add_f32 v41, v41, v53
    v_fmac_f32 v43, v53, v53
    v_lshlrev_b32_e64 v52, 16, v48
    v_and_b32 v53, 0xffff0000, v48
    v_add_f32 v40, v40, v52
    v_fmac_f32 v42, v52, v52
    v_add_f32 v41, v41, v53
    v_fmac_f32 v43, v53, v53
    v_lshlrev_b32_e64 v52, 16, v49
    v_and_b32 v53, 0xffff0000, v49
    v_add_f32 v40, v40, v52
    v_fmac_f32 v42, v52, v52
    v_add_f32 v41, v41, v53
    v_fmac_f32 v43, v53, v53
    v_lshlrev_b32_e64 v52, 16, v50
    v_and_b32 v53, 0xffff0000, v50
    v_add_f32 v40, v40, v52
    v_fmac_f32 v42, v52, v52
    v_add_f32 v41, v41, v53
    v_fmac_f32 v43, v53, v53
    v_lshlrev_b32_e64 v52, 16, v51
    v_and_b32 v53, 0xffff0000, v51
    v_add_f32 v40, v40, v52
    v_fmac_f32 v42, v52, v52
    v_add_f32 v41, v41, v53
    v_fmac_f32 v43, v53, v53
    s_barrier
    ds_read_b128 v[44:47], v32 offset:32768
    ds_read_b128 v[48:51], v32 offset:32784
    s_waitcnt lgkmcnt(0)
    v_lshlrev_b32_e64 v52, 16, v44
    v_and_b32 v53, 0xffff0000, v44
    v_add_f32 v40, v40, v52
    v_fmac_f32 v42, v52, v52
    v_add_f32 v41, v41, v53
    v_fmac_f32 v43, v53, v53
    v_lshlrev_b32_e64 v52, 16, v45
    v_and_b32 v53, 0xffff0000, v45
    v_add_f32 v40, v40, v52
    v_fmac_f32 v42, v52, v52
    v_add_f32 v41, v41, v53
    v_fmac_f32 v43, v53, v53
    v_lshlrev_b32_e64 v52, 16, v46
    v_and_b32 v53, 0xffff0000, v46
    v_add_f32 v40, v40, v52
    v_fmac_f32 v42, v52, v52
    v_add_f32 v41, v41, v53
    v_fmac_f32 v43, v53, v53
    v_lshlrev_b32_e64 v52, 16, v47
    v_and_b32 v53, 0xffff0000, v47
    v_add_f32 v40, v40, v52
    v_fmac_f32 v42, v52, v52
    v_add_f32 v41, v41, v53
    v_fmac_f32 v43, v53, v53
    v_lshlrev_b32_e64 v52, 16, v48
    v_and_b32 v53, 0xffff0000, v48
    v_add_f32 v40, v40, v52
    v_fmac_f32 v42, v52, v52
    v_add_f32 v41, v41, v53
    v_fmac_f32 v43, v53, v53
    v_lshlrev_b32_e64 v52, 16, v49
    v_and_b32 v53, 0xffff0000, v49
    v_add_f32 v40, v40, v52
    v_fmac_f32 v42, v52, v52
    v_add_f32 v41, v41, v53
    v_fmac_f32 v43, v53, v53
    v_lshlrev_b32_e64 v52, 16, v50
    v_and_b32 v53, 0xffff0000, v50
    v_add_f32 v40, v40, v52
    v_fmac_f32 v42, v52, v52
    v_add_f32 v41, v41, v53
    v_fmac_f32 v43, v53, v53
    v_lshlrev_b32_e64 v52, 16, v51
    v_and_b32 v53, 0xffff0000, v51
    v_add_f32 v40, v40, v52
    v_fmac_f32 v42, v52, v52
    v_add_f32 v41, v41, v53
    v_fmac_f32_e64 v43, v53, v53
    s_barrier
    v_add_u32 v32, 0x10000, v32
    ds_read_b128 v[44:47], v32 offset:0
    ds_read_b128 v[48:51], v32 offset:16
    s_cmp_eq_u32 s3, 4
    s_cbranch_scc0 C_aux_nl
    v_mov_b32 v20, 0
    global_load_dword v21, v20, s[20:21] sc1
C_aux_nl:
    s_waitcnt lgkmcnt(0)
    v_lshlrev_b32_e64 v52, 16, v44
    v_and_b32 v53, 0xffff0000, v44
    v_add_f32 v40, v40, v52
    v_fmac_f32 v42, v52, v52
    v_add_f32 v41, v41, v53
    v_fmac_f32 v43, v53, v53
    v_lshlrev_b32_e64 v52, 16, v45
    v_and_b32 v53, 0xffff0000, v45
    v_add_f32 v40, v40, v52
    v_fmac_f32 v42, v52, v52
    v_add_f32 v41, v41, v53
    v_fmac_f32 v43, v53, v53
    v_lshlrev_b32_e64 v52, 16, v46
    v_and_b32 v53, 0xffff0000, v46
    v_add_f32 v40, v40, v52
    v_fmac_f32 v42, v52, v52
    v_add_f32 v41, v41, v53
    v_fmac_f32 v43, v53, v53
    v_lshlrev_b32_e64 v52, 16, v47
    v_and_b32 v53, 0xffff0000, v47
    v_add_f32 v40, v40, v52
    v_fmac_f32 v42, v52, v52
    v_add_f32 v41, v41, v53
    v_fmac_f32 v43, v53, v53
    v_lshlrev_b32_e64 v52, 16, v48
    v_and_b32 v53, 0xffff0000, v48
    v_add_f32 v40, v40, v52
    v_fmac_f32 v42, v52, v52
    v_add_f32 v41, v41, v53
    v_fmac_f32 v43, v53, v53
    v_lshlrev_b32_e64 v52, 16, v49
    v_and_b32 v53, 0xffff0000, v49
    v_add_f32 v40, v40, v52
    v_fmac_f32 v42, v52, v52
    v_add_f32 v41, v41, v53
    v_fmac_f32 v43, v53, v53
    v_lshlrev_b32_e64 v52, 16, v50
    v_and_b32 v53, 0xffff0000, v50
    v_add_f32 v40, v40, v52
    v_fmac_f32 v42, v52, v52
    v_add_f32 v41, v41, v53
    v_fmac_f32 v43, v53, v53
    v_lshlrev_b32_e64 v52, 16, v51
    v_and_b32 v53, 0xffff0000, v51
    v_add_f32 v40, v40, v52
    v_fmac_f32 v42, v52, v52
    v_add_f32 v41, v41, v53
    v_fmac_f32 v43, v53, v53
    s_barrier
    ds_read_b128 v[44:47], v32 offset:32768
    ds_read_b128 v[48:51], v32 offset:32784
    s_waitcnt lgkmcnt(0)
    v_lshlrev_b32_e64 v52, 16, v44
    v_and_b32 v53, 0xffff0000, v44
    v_add_f32 v40, v40, v52
    v_fmac_f32 v42, v52, v52
    v_add_f32 v41, v41, v53
    v_fmac_f32 v43, v53, v53
    v_lshlrev_b32_e64 v52, 16, v45
    v_and_b32 v53, 0xffff0000, v45
    v_add_f32 v40, v40, v52
    v_fmac_f32 v42, v52, v52
    v_add_f32 v41, v41, v53
    v_fmac_f32 v43, v53, v53
    v_lshlrev_b32_e64 v52, 16, v46
    v_and_b32 v53, 0xffff0000, v46
    v_add_f32 v40, v40, v52
    v_fmac_f32 v42, v52, v52
    v_add_f32 v41, v41, v53
    v_fmac_f32 v43, v53, v53
    v_lshlrev_b32_e64 v52, 16, v47
    v_and_b32 v53, 0xffff0000, v47
    v_add_f32 v40, v40, v52
    v_fmac_f32 v42, v52, v52
    v_add_f32 v41, v41, v53
    v_fmac_f32 v43, v53, v53
    v_lshlrev_b32_e64 v52, 16, v48
    v_and_b32 v53, 0xffff0000, v48
    v_add_f32 v40, v40, v52
    v_fmac_f32 v42, v52, v52
    v_add_f32 v41, v41, v53
    v_fmac_f32 v43, v53, v53
    v_lshlrev_b32_e64 v52, 16, v49
    v_and_b32 v53, 0xffff0000, v49
    v_add_f32 v40, v40, v52
    v_fmac_f32 v42, v52, v52
    v_add_f32 v41, v41, v53
    v_fmac_f32 v43, v53, v53
    v_lshlrev_b32_e64 v52, 16, v50
    v_and_b32 v53, 0xffff0000, v50
    v_add_f32 v40, v40, v52
    v_fmac_f32 v42, v52, v52
    v_add_f32 v41, v41, v53
    v_fmac_f32 v43, v53, v53
    v_lshlrev_b32_e64 v52, 16, v51
    v_and_b32 v53, 0xffff0000, v51
    v_add_f32 v40, v40, v52
    v_fmac_f32 v42, v52, v52
    v_add_f32 v41, v41, v53
    v_fmac_f32 v43, v53, v53
    v_add_f32 v40, v40, v41
    v_add_f32_e64 v42, v42, v43
    s_nop 1
    v_add_f32_dpp v40, v40, v40 quad_perm:[1,0,3,2] row_mask:0xf bank_mask:0xf
    s_nop 1
    v_add_f32_dpp v40, v40, v40 quad_perm:[2,3,0,1] row_mask:0xf bank_mask:0xf
    s_nop 1
    v_add_f32_dpp v42, v42, v42 quad_perm:[1,0,3,2] row_mask:0xf bank_mask:0xf
    s_nop 1
    v_add_f32_dpp v42, v42, v42 quad_perm:[2,3,0,1] row_mask:0xf bank_mask:0xf
    s_nop 1
    v_mul_f32 v44, 0xbb000000, v40
    v_mul_f32 v46, 0x3b000000, v42
    v_fma_f32 v46, -v44, v44, v46
    v_max_f32_e64 v46, 0, v46
    v_add_f32 v46, 0x3727c5ac, v46
    v_rsq_f32 v45, v46
    v_lshlrev_b32 v47, 3, v30
    v_add_u32 v47, 65536, v47
    s_nop 0
    ds_write_b64 v47, v[44:45]
    s_cmp_eq_u32 s3, 4
    s_cbranch_scc0 C_aux_e1a
    s_mov_b32 s42, 0
    v_mov_b32 v20, 0
    s_branch C_ctl_chk
C_ctl_poll:
    global_load_dword v21, v20, s[20:21] sc1
C_ctl_chk:
    s_waitcnt vmcnt(0)
    v_readfirstlane_b32 s56, v21
    s_nop 0
    s_cmp_lg_u32 s56, 0
    s_cbranch_scc1 C_ctl_done
    s_sleep 1
    s_add_u32 s42, s42, 1
    s_cmp_lt_u32 s42, 20000
    s_cbranch_scc1 C_ctl_poll
C_ctl_done:
    v_mov_b32 v22, s56
    v_mov_b32 v23, 0
    v_mov_b32 v24, 67584
    ds_write_b64 v24, v[22:23]
C_aux_e1a:
    s_waitcnt lgkmcnt(0)
    s_barrier
    v_mov_b32 v24, 67584
    ds_read_b64 v[22:23], v24
    s_waitcnt lgkmcnt(0)
    v_readfirstlane_b32 s27, v23
    s_barrier
C_p2:
    s_and_b32 s46, s3, 1
    s_lshr_b32 s47, s3, 1
    s_lshl_b32 s48, s98, 1
    s_add_u32 s48, s48, s46
    s_sub_i32 s49, 8, s48
    s_max_i32 s49, s49, 0
    v_and_b32 v1, 31, v0
    v_lshrrev_b32 v2, 5, v0
    s_lshl_b32 s40, s47, 11
    s_lshl_b32 s41, s46, 10
    s_add_u32 s40, s40, s41
    s_add_u32 s40, s40, 90112
    v_lshl_add_u32 v3, v0, 4, s40
    ds_read_b128 v[12:15], v3
    s_mul_i32 s50, s47, 10240
    s_lshl_b32 s41, s46, 10
    s_add_u32 s50, s50, s41
    v_bfe_u32 v4, v0, 3, 1
    v_xor_b32 v4, v4, v2
    v_lshlrev_b32 v4, 4, v4
    v_lshl_add_u32 v4, v1, 5, v4
    v_add_u32_e64 v7, s50, v4
    v_bfe_u32 v4, v0, 4, 1
    v_bfe_u32 v5, v0, 2, 2
    v_lshl_add_u32 v5, v2, 2, v5
    v_lshlrev_b32 v6, 2, v4
    v_xor_b32 v5, v5, v6
    v_lshl_add_u32 v5, v4, 4, v5
    v_and_b32 v6, 3, v0
    v_lshlrev_b32 v6, 3, v6
    v_lshl_add_u32 v5, v5, 5, v6
    s_add_u32 s41, s50, 40960
    v_add_u32 v8, s41, v5
    s_mov_b32 s64, 0xffffffff
    s_mov_b32 s65, 0xfffffff0
    s_mov_b32 s66, 0xfffffffe
    s_mov_b32 s67, 0xffffffe0
    s_mov_b32 s68, 0xfffffffc
    s_mov_b32 s69, 0xffffffc0
    s_mov_b32 s70, 0xfffffff8
    s_mov_b32 s71, 0xffffff80
    s_mov_b32 s72, 0xffffff00
    s_mov_b32 s73, 0xfffff000
    s_mov_b32 s74, 0xfffffe00
    s_mov_b32 s75, 0xffffe000
    s_mov_b32 s76, 0xfffffc00
    s_mov_b32 s77, 0xffffc000
    s_mov_b32 s78, 0xfffff800
    s_mov_b32 s79, 0xffff8000
    s_mov_b32 s80, 0xffff0000
    s_mov_b32 s81, 0xfff00000
    s_mov_b32 s82, 0xfffe0000
    s_mov_b32 s83, 0xffe00000
    s_mov_b32 s84, 0xfffc0000
    s_mov_b32 s85, 0xffc00000
    s_mov_b32 s86, 0xfff80000
    s_mov_b32 s87, 0xff800000
    s_mov_b32 s88, 0xff000000
    s_mov_b32 s89, 0xf0000000
    s_mov_b32 s90, 0xfe000000
    s_mov_b32 s91, 0xe0000000
    s_mov_b32 s92, 0xfc000000
    s_mov_b32 s93, 0xc0000000
    s_mov_b32 s94, 0xf8000000
    s_mov_b32 s95, 0x80000000
    v_mov_b32 v3, 0xffff
    v_mov_b32 v4, 0xffff0000
    v_cndmask_b32_e64 v44, 0, v3, s[64:65]
    v_cndmask_b32_e64 v5, 0, v4, s[66:67]
    v_or_b32 v44, v44, v5
    v_cndmask_b32_e64 v45, 0, v3, s[68:69]
    v_cndmask_b32_e64 v5, 0, v4, s[70:71]
    v_or_b32_e64 v45, v45, v5
    v_cndmask_b32_e64 v46, 0, v3, s[72:73]
    v_cndmask_b32_e64 v5, 0, v4, s[74:75]
    v_or_b32_e64 v46, v46, v5
    v_cndmask_b32_e64 v47, 0, v3, s[76:77]
    v_cndmask_b32_e64 v5, 0, v4, s[78:79]
    v_or_b32_e64 v47, v47, v5
    v_cndmask_b32_e64 v48, 0, v3, s[80:81]
    v_cndmask_b32_e64 v5, 0, v4, s[82:83]
    v_or_b32_e64 v48, v48, v5
    v_cndmask_b32_e64 v49, 0, v3, s[84:85]
    v_cndmask_b32_e64 v5, 0, v4, s[86:87]
    v_or_b32_e64 v49, v49, v5
    v_cndmask_b32_e64 v50, 0, v3, s[88:89]
    v_cndmask_b32_e64 v5, 0, v4, s[90:91]
    v_or_b32_e64 v50, v50, v5
    v_cndmask_b32_e64 v51, 0, v3, s[92:93]
    v_cndmask_b32_e64 v5, 0, v4, s[94:95]
    v_or_b32_e64 v51, v51, v5
    v_mov_b32 v32, 0x3f803f80
    v_mov_b32 v33, 0x3f803f80
    v_mov_b32 v34, 0x3f803f80
    v_mov_b32 v35, 0x3f803f80
    s_cmp_gt_u32 s49, 0
    s_cselect_b32 s40, 0xf149f2ca, 0
    v_mov_b32 v100, s40
    v_mov_b32 v101, s40
    v_mov_b32 v102, s40
    v_mov_b32 v103, s40
    v_mov_b32 v104, s40
    v_mov_b32 v105, s40
    v_mov_b32 v106, s40
    v_mov_b32 v107, s40
    v_mov_b32 v108, s40
    v_mov_b32 v109, s40
    v_mov_b32 v110, s40
    v_mov_b32 v111, s40
    v_mov_b32 v112, s40
    v_mov_b32 v113, s40
    v_mov_b32 v114, s40
    v_mov_b32_e64 v115, s40
    v_mov_b32 v10, 0xf149f2ca
    v_mov_b32 v6, 0xf149f2ca
    s_barrier
    s_mov_b32 s51, 0
    ds_read_b128 v[16:19], v7 offset:0
    ds_read_b128 v[20:23], v7 offset:8192
    s_waitcnt lgkmcnt(0)
    v_mfma_f32_32x32x16_bf16 v[52:67], v[16:19], v[12:15], v[100:115]
    v_mfma_f32_32x32x16_bf16 v[68:83], v[20:23], v[12:15], 0
    ds_read_b128 v[16:19], v7 offset:1024
    ds_read_b128 v[20:23], v7 offset:2048
    s_nop 9
    v_cndmask_b32_e64 v84, v52, v68, s[64:65]
    v_cndmask_b32_e64 v85, v53, v69, s[66:67]
    v_cndmask_b32_e64 v86, v54, v70, s[68:69]
    v_cndmask_b32_e64 v87, v55, v71, s[70:71]
    v_cndmask_b32_e64 v88, v56, v72, s[72:73]
    v_cndmask_b32_e64 v89, v57, v73, s[74:75]
    v_cndmask_b32_e64 v90, v58, v74, s[76:77]
    v_cndmask_b32_e64 v91, v59, v75, s[78:79]
    v_cndmask_b32_e64 v92, v60, v76, s[80:81]
    v_cndmask_b32_e64 v93, v61, v77, s[82:83]
    v_cndmask_b32_e64 v94, v62, v78, s[84:85]
    v_cndmask_b32_e64 v95, v63, v79, s[86:87]
    v_cndmask_b32_e64 v96, v64, v80, s[88:89]
    v_cndmask_b32_e64 v97, v65, v81, s[90:91]
    v_cndmask_b32_e64 v98, v66, v82, s[92:93]
    v_cndmask_b32_e64 v99, v67, v83, s[94:95]
    v_max3_f32 v10, v10, v84, v85
    v_max3_f32 v6, v6, v86, v87
    v_max3_f32 v10, v10, v88, v89
    v_max3_f32 v6, v6, v90, v91
    v_max3_f32 v10, v10, v92, v93
    v_max3_f32 v6, v6, v94, v95
    v_max3_f32 v10, v10, v96, v97
    v_max3_f32 v6, v6, v98, v99
    v_max_f32 v10, v10, v6
    v_mov_b32 v1, v10
    s_nop 1
    v_permlane32_swap_b32 v10, v1
    v_max_f32 v10, v10, v1
    v_sub_f32 v10, 0, v10
    s_cmp_gt_u32 s49, 1
    s_cselect_b64 s[40:41], -1, 0
    v_mov_b32 v2, 0xf149f2ca
    v_cndmask_b32_e64 v3, v10, v2, s[40:41]
    v_mov_b32 v100, v3
    v_mov_b32 v101, v3
    v_mov_b32 v102, v3
    v_mov_b32 v103, v3
    v_mov_b32 v104, v3
    v_mov_b32 v105, v3
    v_mov_b32 v106, v3
    v_mov_b32 v107, v3
    v_mov_b32 v108, v3
    v_mov_b32 v109, v3
    v_mov_b32 v110, v3
    v_mov_b32 v111, v3
    v_mov_b32 v112, v3
    v_mov_b32 v113, v3
    v_mov_b32 v114, v3
    v_mov_b32 v115, v3
    s_barrier
C_p2_entry:
    ds_read_b64_tr_b16 v[24:25], v8 offset:0
    ds_read_b64_tr_b16 v[26:27], v8 offset:256
    ds_read_b64_tr_b16 v[28:29], v8 offset:8192
    ds_read_b64_tr_b16 v[30:31], v8 offset:8448
    s_waitcnt lgkmcnt(4)
    v_mfma_f32_32x32x16_bf16 v[52:67], v[16:19], v[12:15], v[100:115]
    ds_read_b128 v[16:19], v7 offset:3072
    v_pk_add_f32 v[84:85], v[84:85], v[10:11] op_sel_hi:[1,0]
    v_pk_add_f32 v[86:87], v[86:87], v[10:11] op_sel_hi:[1,0]
    v_pk_add_f32 v[88:89], v[88:89], v[10:11] op_sel_hi:[1,0]
    v_pk_add_f32 v[90:91], v[90:91], v[10:11] op_sel_hi:[1,0]
    v_pk_add_f32 v[92:93], v[92:93], v[10:11] op_sel_hi:[1,0]
    v_pk_add_f32 v[94:95], v[94:95], v[10:11] op_sel_hi:[1,0]
    v_pk_add_f32 v[96:97], v[96:97], v[10:11] op_sel_hi:[1,0]
    v_pk_add_f32 v[98:99], v[98:99], v[10:11] op_sel_hi:[1,0]
    v_exp_f32 v84, v84
    v_exp_f32 v85, v85
    v_exp_f32 v86, v86
    v_exp_f32 v87, v87
    v_cvt_pk_bf16_f32 v36, v84, v85
    v_exp_f32 v88, v88
    v_exp_f32 v89, v89
    v_cvt_pk_bf16_f32 v37, v86, v87
    v_exp_f32 v90, v90
    v_exp_f32 v91, v91
    v_cvt_pk_bf16_f32 v38, v88, v89
    v_exp_f32 v92, v92
    v_exp_f32 v93, v93
    v_cvt_pk_bf16_f32 v39, v90, v91
    v_exp_f32 v94, v94
    v_exp_f32 v95, v95
    v_cvt_pk_bf16_f32 v40, v92, v93
    v_exp_f32 v96, v96
    v_exp_f32 v97, v97
    v_cvt_pk_bf16_f32 v41, v94, v95
    v_exp_f32 v98, v98
    v_exp_f32 v99, v99
    v_cvt_pk_bf16_f32 v42, v96, v97
    s_nop 0
    v_cvt_pk_bf16_f32 v43, v98, v99
    v_and_b32 v44, v36, v44
    v_and_b32 v45, v37, v45
    v_and_b32 v46, v38, v46
    v_and_b32 v47, v39, v47
    v_and_b32 v48, v40, v48
    v_and_b32 v49, v41, v49
    v_and_b32 v50, v42, v50
    v_and_b32 v51, v43, v51
    v_xor_b32 v84, v36, v44
    v_xor_b32 v85, v37, v45
    v_xor_b32 v86, v38, v46
    v_xor_b32 v87, v39, v47
    v_xor_b32 v88, v40, v48
    v_xor_b32 v89, v41, v49
    v_xor_b32 v90, v42, v50
    v_xor_b32 v91, v43, v51
    s_waitcnt lgkmcnt(1)
    v_mfma_f32_32x32x16_bf16 v[148:163], v[32:35], v[36:39], 0
    v_mfma_f32_32x32x16_bf16 v[116:131], v[28:31], v[44:47], 0
    v_mfma_f32_32x32x16_bf16 v[132:147], v[28:31], v[48:51], 0
    v_mfma_f32_32x32x16_bf16 v[148:163], v[32:35], v[40:43], v[148:163]
    ds_read_b64_tr_b16 v[28:29], v8 offset:1024
    ds_read_b64_tr_b16 v[30:31], v8 offset:1280
    s_cmp_eq_u32 s49, 2
    s_cbranch_scc1 sw_p2s2
sw_p2s2_back:
    s_waitcnt lgkmcnt(3)
    v_mfma_f32_32x32x16_bf16 v[68:83], v[20:23], v[12:15], v[100:115]
    ds_read_b128 v[20:23], v7 offset:4096
    v_exp_f32 v52, v52
    v_exp_f32 v53, v53
    v_exp_f32 v54, v54
    v_exp_f32_e64 v55, v55
    v_cvt_pk_bf16_f32 v36, v52, v53
    v_mfma_f32_32x32x16_bf16 v[116:131], v[24:27], v[84:87], v[116:131]
    v_exp_f32 v56, v56
    v_exp_f32 v57, v57
    v_cvt_pk_bf16_f32 v37, v54, v55
    v_exp_f32 v58, v58
    v_exp_f32 v59, v59
    v_cvt_pk_bf16_f32 v38, v56, v57
    v_mfma_f32_32x32x16_bf16 v[132:147], v[24:27], v[88:91], v[132:147]
    v_exp_f32 v60, v60
    v_exp_f32 v61, v61
    v_cvt_pk_bf16_f32 v39, v58, v59
    v_exp_f32 v62, v62
    v_exp_f32 v63, v63
    v_cvt_pk_bf16_f32 v40, v60, v61
    v_exp_f32 v64, v64
    v_exp_f32 v65, v65
    v_cvt_pk_bf16_f32 v41, v62, v63
    v_exp_f32 v66, v66
    v_exp_f32 v67, v67
    v_cvt_pk_bf16_f32 v42, v64, v65
    s_nop 0
    v_cvt_pk_bf16_f32 v43, v66, v67
    s_waitcnt lgkmcnt(1)
    ds_read_b64_tr_b16 v[24:25], v8 offset:2048
    ds_read_b64_tr_b16 v[26:27], v8 offset:2304
    s_cmp_eq_u32 s49, 3
    s_cbranch_scc1 sw_p2s3
sw_p2s3_back:
    s_waitcnt lgkmcnt(3)
    v_mfma_f32_32x32x16_bf16 v[52:67], v[16:19], v[12:15], v[100:115]
    ds_read_b128 v[16:19], v7 offset:5120
    v_exp_f32 v68, v68
    v_exp_f32 v69, v69
    v_exp_f32 v70, v70
    v_exp_f32_e64 v71, v71
    v_cvt_pk_bf16_f32 v44, v68, v69
    v_mfma_f32_32x32x16_bf16 v[116:131], v[28:31], v[36:39], v[116:131]
    v_exp_f32 v72, v72
    v_exp_f32 v73, v73
    v_cvt_pk_bf16_f32 v45, v70, v71
    v_exp_f32 v74, v74
    v_exp_f32 v75, v75
    v_cvt_pk_bf16_f32 v46, v72, v73
    v_mfma_f32_32x32x16_bf16 v[148:163], v[32:35], v[36:39], v[148:163]
    v_exp_f32 v76, v76
    v_exp_f32 v77, v77
    v_cvt_pk_bf16_f32 v47, v74, v75
    v_exp_f32 v78, v78
    v_exp_f32 v79, v79
    v_cvt_pk_bf16_f32 v48, v76, v77
    v_mfma_f32_32x32x16_bf16 v[132:147], v[28:31], v[40:43], v[132:147]
    v_exp_f32 v80, v80
    v_exp_f32 v81, v81
    v_cvt_pk_bf16_f32 v49, v78, v79
    v_exp_f32 v82, v82
    v_exp_f32 v83, v83
    v_cvt_pk_bf16_f32 v50, v80, v81
    v_mfma_f32_32x32x16_bf16 v[148:163], v[32:35], v[40:43], v[148:163]
    s_nop 0
    v_cvt_pk_bf16_f32 v51, v82, v83
    s_waitcnt lgkmcnt(1)
    ds_read_b64_tr_b16 v[28:29], v8 offset:3072
    ds_read_b64_tr_b16 v[30:31], v8 offset:3328
    s_cmp_eq_u32 s49, 4
    s_cbranch_scc1 sw_p2s4
sw_p2s4_back:
    s_waitcnt lgkmcnt(3)
    v_mfma_f32_32x32x16_bf16 v[68:83], v[20:23], v[12:15], v[100:115]
    ds_read_b128 v[20:23], v7 offset:6144
    v_exp_f32 v52, v52
    v_exp_f32 v53, v53
    v_exp_f32 v54, v54
    v_exp_f32_e64 v55, v55
    v_cvt_pk_bf16_f32 v36, v52, v53
    v_mfma_f32_32x32x16_bf16 v[116:131], v[24:27], v[44:47], v[116:131]
    v_exp_f32 v56, v56
    v_exp_f32 v57, v57
    v_cvt_pk_bf16_f32 v37, v54, v55
    v_exp_f32 v58, v58
    v_exp_f32 v59, v59
    v_cvt_pk_bf16_f32 v38, v56, v57
    v_mfma_f32_32x32x16_bf16 v[148:163], v[32:35], v[44:47], v[148:163]
    v_exp_f32 v60, v60
    v_exp_f32 v61, v61
    v_cvt_pk_bf16_f32 v39, v58, v59
    v_exp_f32 v62, v62
    v_exp_f32 v63, v63
    v_cvt_pk_bf16_f32 v40, v60, v61
    v_mfma_f32_32x32x16_bf16 v[132:147], v[24:27], v[48:51], v[132:147]
    v_exp_f32 v64, v64
    v_exp_f32 v65, v65
    v_cvt_pk_bf16_f32 v41, v62, v63
    v_exp_f32 v66, v66
    v_exp_f32 v67, v67
    v_cvt_pk_bf16_f32 v42, v64, v65
    v_mfma_f32_32x32x16_bf16 v[148:163], v[32:35], v[48:51], v[148:163]
    s_nop 0
    v_cvt_pk_bf16_f32 v43, v66, v67
    s_waitcnt lgkmcnt(1)
    ds_read_b64_tr_b16 v[24:25], v8 offset:4096
    ds_read_b64_tr_b16 v[26:27], v8 offset:4352
    s_cmp_eq_u32 s49, 5
    s_cbranch_scc1 sw_p2s5
sw_p2s5_back:
    s_waitcnt lgkmcnt(3)
    v_mfma_f32_32x32x16_bf16 v[52:67], v[16:19], v[12:15], v[100:115]
    ds_read_b128 v[16:19], v7 offset:7168
    v_exp_f32 v68, v68
    v_exp_f32 v69, v69
    v_exp_f32 v70, v70
    v_exp_f32_e64 v71, v71
    v_cvt_pk_bf16_f32 v44, v68, v69
    v_mfma_f32_32x32x16_bf16 v[116:131], v[28:31], v[36:39], v[116:131]
    v_exp_f32 v72, v72
    v_exp_f32 v73, v73
    v_cvt_pk_bf16_f32 v45, v70, v71
    v_exp_f32 v74, v74
    v_exp_f32 v75, v75
    v_cvt_pk_bf16_f32 v46, v72, v73
    v_mfma_f32_32x32x16_bf16 v[148:163], v[32:35], v[36:39], v[148:163]
    v_exp_f32 v76, v76
    v_exp_f32 v77, v77
    v_cvt_pk_bf16_f32 v47, v74, v75
    v_exp_f32 v78, v78
    v_exp_f32 v79, v79
    v_cvt_pk_bf16_f32 v48, v76, v77
    v_mfma_f32_32x32x16_bf16 v[132:147], v[28:31], v[40:43], v[132:147]
    v_exp_f32 v80, v80
    v_exp_f32 v81, v81
    v_cvt_pk_bf16_f32 v49, v78, v79
    v_exp_f32 v82, v82
    v_exp_f32 v83, v83
    v_cvt_pk_bf16_f32 v50, v80, v81
    v_mfma_f32_32x32x16_bf16 v[148:163], v[32:35], v[40:43], v[148:163]
    s_nop 0
    v_cvt_pk_bf16_f32 v51, v82, v83
    s_waitcnt lgkmcnt(1)
    ds_read_b64_tr_b16 v[28:29], v8 offset:5120
    ds_read_b64_tr_b16 v[30:31], v8 offset:5376
    s_cmp_eq_u32 s49, 6
    s_cbranch_scc1 sw_p2s6
sw_p2s6_back:
    s_waitcnt lgkmcnt(3)
    v_mfma_f32_32x32x16_bf16 v[68:83], v[20:23], v[12:15], v[100:115]
    v_exp_f32 v52, v52
    v_exp_f32 v53, v53
    v_exp_f32 v54, v54
    v_exp_f32_e64 v55, v55
    v_cvt_pk_bf16_f32 v36, v52, v53
    v_mfma_f32_32x32x16_bf16 v[116:131], v[24:27], v[44:47], v[116:131]
    v_exp_f32 v56, v56
    v_exp_f32 v57, v57
    v_cvt_pk_bf16_f32 v37, v54, v55
    v_exp_f32 v58, v58
    v_exp_f32 v59, v59
    v_cvt_pk_bf16_f32 v38, v56, v57
    v_mfma_f32_32x32x16_bf16 v[148:163], v[32:35], v[44:47], v[148:163]
    v_exp_f32 v60, v60
    v_exp_f32 v61, v61
    v_cvt_pk_bf16_f32 v39, v58, v59
    v_exp_f32 v62, v62
    v_exp_f32 v63, v63
    v_cvt_pk_bf16_f32 v40, v60, v61
    v_mfma_f32_32x32x16_bf16 v[132:147], v[24:27], v[48:51], v[132:147]
    v_exp_f32 v64, v64
    v_exp_f32 v65, v65
    v_cvt_pk_bf16_f32 v41, v62, v63
    v_exp_f32 v66, v66
    v_exp_f32 v67, v67
    v_cvt_pk_bf16_f32 v42, v64, v65
    v_mfma_f32_32x32x16_bf16 v[148:163], v[32:35], v[48:51], v[148:163]
    s_nop 0
    v_cvt_pk_bf16_f32 v43, v66, v67
    s_waitcnt lgkmcnt(0)
    ds_read_b64_tr_b16 v[24:25], v8 offset:6144
    ds_read_b64_tr_b16 v[26:27], v8 offset:6400
    s_cmp_eq_u32 s49, 7
    s_cbranch_scc1 sw_p2s7
sw_p2s7_back:
    s_waitcnt lgkmcnt(2)
    v_mfma_f32_32x32x16_bf16 v[52:67], v[16:19], v[12:15], v[100:115]
    v_exp_f32 v68, v68
    v_exp_f32 v69, v69
    v_exp_f32 v70, v70
    v_exp_f32_e64 v71, v71
    v_cvt_pk_bf16_f32 v44, v68, v69
    v_mfma_f32_32x32x16_bf16 v[116:131], v[28:31], v[36:39], v[116:131]
    v_exp_f32 v72, v72
    v_exp_f32 v73, v73
    v_cvt_pk_bf16_f32 v45, v70, v71
    v_exp_f32 v74, v74
    v_exp_f32 v75, v75
    v_cvt_pk_bf16_f32 v46, v72, v73
    v_mfma_f32_32x32x16_bf16 v[148:163], v[32:35], v[36:39], v[148:163]
    v_exp_f32 v76, v76
    v_exp_f32 v77, v77
    v_cvt_pk_bf16_f32 v47, v74, v75
    v_exp_f32 v78, v78
    v_exp_f32 v79, v79
    v_cvt_pk_bf16_f32 v48, v76, v77
    v_mfma_f32_32x32x16_bf16 v[132:147], v[28:31], v[40:43], v[132:147]
    v_exp_f32 v80, v80
    v_exp_f32 v81, v81
    v_cvt_pk_bf16_f32 v49, v78, v79
    v_exp_f32 v82, v82
    v_exp_f32 v83, v83
    v_cvt_pk_bf16_f32 v50, v80, v81
    v_mfma_f32_32x32x16_bf16 v[148:163], v[32:35], v[40:43], v[148:163]
    s_nop 0
    v_cvt_pk_bf16_f32 v51, v82, v83
    s_waitcnt lgkmcnt(0)
    ds_read_b64_tr_b16 v[28:29], v8 offset:7168
    ds_read_b64_tr_b16 v[30:31], v8 offset:7424
    v_exp_f32 v52, v52
    v_exp_f32 v53, v53
    v_exp_f32 v54, v54
    v_exp_f32 v55, v55
    v_cvt_pk_bf16_f32 v36, v52, v53
    v_mfma_f32_32x32x16_bf16 v[116:131], v[24:27], v[44:47], v[116:131]
    v_exp_f32 v56, v56
    v_exp_f32 v57, v57
    v_cvt_pk_bf16_f32 v37, v54, v55
    v_exp_f32 v58, v58
    v_exp_f32 v59, v59
    v_cvt_pk_bf16_f32 v38, v56, v57
    v_mfma_f32_32x32x16_bf16 v[148:163], v[32:35], v[44:47], v[148:163]
    v_exp_f32 v60, v60
    v_exp_f32 v61, v61
    v_cvt_pk_bf16_f32 v39, v58, v59
    v_exp_f32 v62, v62
    v_exp_f32 v63, v63
    v_cvt_pk_bf16_f32 v40, v60, v61
    v_mfma_f32_32x32x16_bf16 v[132:147], v[24:27], v[48:51], v[132:147]
    v_exp_f32 v64, v64
    v_exp_f32 v65, v65
    v_cvt_pk_bf16_f32 v41, v62, v63
    v_exp_f32 v66, v66
    v_exp_f32 v67, v67
    v_cvt_pk_bf16_f32 v42, v64, v65
    v_mfma_f32_32x32x16_bf16 v[148:163], v[32:35], v[48:51], v[148:163]
    s_nop 0
    v_cvt_pk_bf16_f32 v43, v66, v67
    s_waitcnt lgkmcnt(0)
    v_mfma_f32_32x32x16_bf16 v[116:131], v[28:31], v[36:39], v[116:131]
    v_mfma_f32_32x32x16_bf16 v[148:163], v[32:35], v[36:39], v[148:163]
    v_mfma_f32_32x32x16_bf16 v[132:147], v[28:31], v[40:43], v[132:147]
    v_mfma_f32_32x32x16_bf16 v[148:163], v[32:35], v[40:43], v[148:163]
    s_nop 7
    s_nop 3
    v_mov_b32 v1, 0x71800000
    v_cmp_gt_f32 vcc, v1, v148
    s_nop 1
    s_cmp_eq_u64 vcc, -1
    s_cselect_b32 s40, 1, s51
    s_cmp_eq_u32 s40, 0
    s_cbranch_scc1 C_p2_exact
    v_and_b32 v1, 31, v0
    v_lshrrev_b32 v2, 5, v0
    v_bfe_u32 v3, v0, 1, 3
    s_lshl_b32 s40, s47, 1
    v_add_u32 v4, s40, v2
    v_xor_b32 v3, v3, v4
    v_lshlrev_b32 v3, 4, v3
    v_lshl_add_u32 v3, v1, 7, v3
    s_lshl_b32 s40, s46, 12
    s_add_u32 s40, s40, 81920
    v_add_u32 v5, s40, v3
    s_lshl_b32 s40, s3, 10
    s_add_u32 s41, s40, 81920
    v_lshl_add_u32 v3, v0, 4, s41
    s_add_u32 s28, s22, 0x500000
    s_addc_u32 s29, s23, 0
    s_mov_b32 s30, 0x200000
    s_mov_b32 s31, 0x20000
    s_lshl_b32 s42, s98, 3
    s_add_u32 s42, s42, s99
    s_lshl_b32 s42, s42, 13
    s_add_u32 s42, s42, s40
    v_lshlrev_b32 v4, 4, v0
    v_rcp_f32 v1, v148
    v_add_f32 v116, v116, v140
    v_add_f32 v117, v117, v141
    v_add_f32 v118, v118, v142
    v_add_f32 v119, v119, v143
    v_add_f32 v120, v120, v144
    v_add_f32 v121, v121, v145
    v_add_f32 v122, v122, v146
    v_add_f32 v123, v123, v147
    v_mul_f32 v116, v116, v1
    v_mul_f32 v117, v117, v1
    v_mul_f32 v118, v118, v1
    v_mul_f32 v119, v119, v1
    v_mul_f32 v120, v120, v1
    v_mul_f32 v121, v121, v1
    v_mul_f32 v122, v122, v1
    v_mul_f32 v123, v123, v1
    v_cvt_pk_bf16_f32 v36, v116, v117
    v_cvt_pk_bf16_f32 v37, v118, v119
    v_cvt_pk_bf16_f32 v38, v120, v121
    v_cvt_pk_bf16_f32 v39, v122, v123
    ds_write_b128 v5, v[36:39]
    s_waitcnt lgkmcnt(0)
    s_barrier
    ds_read_b128 v[36:39], v3
    v_mov_b32 v1, 90112
    ds_read_b32 v2, v1
    s_waitcnt lgkmcnt(0)
    v_readfirstlane_b32 s27, v2
    buffer_store_dwordx4 v[36:39], v4, s[28:31], s42 offen sc1
    s_waitcnt vmcnt(0)
    s_barrier
    s_lshl_b32 s56, s24, 2
    s_lshr_b32 s40, s25, 3
    s_add_u32 s56, s56, s40
    s_and_b32 s57, s25, 7
    s_lshl_b32 s58, s24, 1
    s_and_b32 s40, s25, 1
    s_add_u32 s58, s58, s40
    s_lshr_b32 s59, s25, 1
    s_and_b32 s46, s3, 1
    s_bfe_u32 s47, s3, 0x10001
    s_lshr_b32 s48, s3, 2
    v_and_b32 v89, 31, v0
    v_lshrrev_b32_e64 v90, 5, v0
    s_lshl_b32 s49, s48, 13
    v_bfe_u32 v91, v0, 1, 3
    v_xor_b32 v91, v91, v90
    v_lshlrev_b32_e64 v91, 4, v91
    s_lshl_b32 s40, s46, 12
    v_lshl_add_u32 v92, v89, 7, v91
    v_add_u32 v84, s40, v92
    v_add_u32 v84, s49, v84
    v_xor_b32 v85, 32, v84
    v_xor_b32 v86, 64, v84
    v_xor_b32 v87, 96, v84
    v_bfe_u32 v91, v0, 2, 2
    v_lshl_add_u32 v92, v90, 3, v91
    v_bfe_u32 v93, v0, 4, 1
    v_bfe_u32 v94, v0, 1, 1
    v_lshl_add_u32 v93, v93, 1, v94
    s_lshl_b32 s40, s47, 2
    v_add_u32 v93, s40, v93
    v_bfe_u32 v94, v0, 3, 1
    v_lshlrev_b32 v94, 2, v94
    v_xor_b32 v93, v93, v94
    v_lshlrev_b32_e64 v93, 4, v93
    v_lshl_add_u32 v93, v92, 7, v93
    v_and_b32_e64 v94, 1, v0
    v_lshl_add_u32 v88, v94, 3, v93
    v_add_u32 v88, 98304, v88
    v_add_u32 v88, s49, v88
    s_mov_b32 s28, s4
    s_mov_b32 s29, s5
    s_mov_b32 s30, 0x200000
    s_mov_b32 s31, 0x20000
    s_lshl_b32 s50, s56, 16
    s_lshl_b32 s40, s46, 15
    s_add_u32 s50, s50, s40
    s_lshl_b32 s40, s57, 7
    s_add_u32 s50, s50, s40
    s_lshl_b32 s40, s47, 6
    s_add_u32 s50, s50, s40
    s_lshl_b32 s40, s48, 5
    s_add_u32 s50, s50, s40
    v_lshlrev_b32_e64 v95, 10, v89
    v_lshl_add_u32 v95, v90, 3, v95
    buffer_load_dwordx2 v[108:109], v95, s[28:31], s50 offen
    buffer_load_dwordx2 v[110:111], v95, s[28:31], s50 offen offset:16
    v_lshlrev_b32 v115, 4, v0
    s_xor_b32 s40, s3, 4
    s_lshl_b32 s40, s40, 11
    s_add_u32 s40, s40, 65536
    v_add_u32 v112, s40, v115
    s_lshl_b32 s40, s3, 11
    s_add_u32 s40, s40, 65536
    v_add_u32 v113, s40, v115
    s_lshl_b32 s51, s47, 1
    s_add_u32 s51, s51, s48
    s_lshl_b32 s40, s51, 1
    v_add_u32 v92, s40, v90
    v_bfe_u32 v91, v0, 1, 3
    v_xor_b32 v91, v91, v92
    v_lshlrev_b32 v91, 4, v91
    v_lshl_add_u32 v91, v89, 7, v91
    s_lshl_b32 s40, s46, 12
    s_add_u32 s40, s40, 81920
    v_add_u32 v114, s40, v91
    s_lshl_b32 s40, s3, 10
    s_add_u32 s41, s40, 81920
    v_add_u32 v116, s41, v115
    s_barrier
    ds_read_b128 v[20:23], v84 offset:0
    ds_read_b64_tr_b16 v[24:25], v88 offset:0
    ds_read_b64_tr_b16 v[26:27], v88 offset:512
    ds_read_b128 v[28:31], v85 offset:0
    ds_read_b64_tr_b16 v[32:33], v88 offset:2048
    ds_read_b64_tr_b16 v[34:35], v88 offset:2560
    ds_read_b128 v[36:39], v86 offset:0
    ds_read_b64_tr_b16 v[40:41], v88 offset:4096
    ds_read_b64_tr_b16 v[42:43], v88 offset:4608
    ds_read_b128 v[44:47], v87 offset:0
    ds_read_b64_tr_b16 v[48:49], v88 offset:6144
    ds_read_b64_tr_b16 v[50:51], v88 offset:6656
    s_waitcnt lgkmcnt(0)
    s_barrier
    ds_read_b128 v[52:55], v84 offset:16384
    ds_read_b64_tr_b16 v[56:57], v88 offset:16384
    ds_read_b64_tr_b16 v[58:59], v88 offset:16896
    ds_read_b128 v[60:63], v85 offset:16384
    ds_read_b64_tr_b16 v[64:65], v88 offset:18432
    ds_read_b64_tr_b16 v[66:67], v88 offset:18944
    ds_read_b128 v[68:71], v86 offset:16384
    ds_read_b64_tr_b16 v[72:73], v88 offset:20480
    ds_read_b64_tr_b16 v[74:75], v88 offset:20992
    ds_read_b128 v[76:79], v87 offset:16384
    ds_read_b64_tr_b16 v[80:81], v88 offset:22528
    ds_read_b64_tr_b16 v[82:83], v88 offset:23040
    v_mfma_f32_32x32x16_bf16 v[4:19], v[24:27], v[20:23], 0
    v_mfma_f32_32x32x16_bf16 v[4:19], v[32:35], v[28:31], v[4:19]
    v_mfma_f32_32x32x16_bf16 v[4:19], v[40:43], v[36:39], v[4:19]
    v_mfma_f32_32x32x16_bf16 v[4:19], v[48:51], v[44:47], v[4:19]
    s_waitcnt lgkmcnt(0)
    s_barrier
    ds_read_b128 v[20:23], v84 offset:32768
    ds_read_b64_tr_b16 v[24:25], v88 offset:32768
    ds_read_b64_tr_b16 v[26:27], v88 offset:33280
    ds_read_b128 v[28:31], v85 offset:32768
    ds_read_b64_tr_b16 v[32:33], v88 offset:34816
    ds_read_b64_tr_b16 v[34:35], v88 offset:35328
    ds_read_b128 v[36:39], v86 offset:32768
    ds_read_b64_tr_b16 v[40:41], v88 offset:36864
    ds_read_b64_tr_b16 v[42:43], v88 offset:37376
    ds_read_b128 v[44:47], v87 offset:32768
    ds_read_b64_tr_b16 v[48:49], v88 offset:38912
    ds_read_b64_tr_b16 v[50:51], v88 offset:39424
    v_mfma_f32_32x32x16_bf16 v[4:19], v[56:59], v[52:55], v[4:19]
    v_mfma_f32_32x32x16_bf16 v[4:19], v[64:67], v[60:63], v[4:19]
    v_mfma_f32_32x32x16_bf16 v[4:19], v[72:75], v[68:71], v[4:19]
    v_mfma_f32_32x32x16_bf16 v[4:19], v[80:83], v[76:79], v[4:19]
    s_waitcnt lgkmcnt(0)
    s_barrier
    ds_read_b128 v[52:55], v84 offset:49152
    ds_read_b64_tr_b16 v[56:57], v88 offset:49152
    ds_read_b64_tr_b16 v[58:59], v88 offset:49664
    ds_read_b128 v[60:63], v85 offset:49152
    ds_read_b64_tr_b16 v[64:65], v88 offset:51200
    ds_read_b64_tr_b16 v[66:67], v88 offset:51712
    ds_read_b128 v[68:71], v86 offset:49152
    ds_read_b64_tr_b16 v[72:73], v88 offset:53248
    ds_read_b64_tr_b16 v[74:75], v88 offset:53760
    ds_read_b128 v[76:79], v87 offset:49152
    ds_read_b64_tr_b16 v[80:81], v88 offset:55296
    ds_read_b64_tr_b16 v[82:83], v88 offset:55808
    v_mfma_f32_32x32x16_bf16 v[4:19], v[24:27], v[20:23], v[4:19]
    v_mfma_f32_32x32x16_bf16 v[4:19], v[32:35], v[28:31], v[4:19]
    v_mfma_f32_32x32x16_bf16 v[4:19], v[40:43], v[36:39], v[4:19]
    v_mfma_f32_32x32x16_bf16 v[4:19], v[48:51], v[44:47], v[4:19]
    s_waitcnt lgkmcnt(0)
    v_mfma_f32_32x32x16_bf16 v[4:19], v[56:59], v[52:55], v[4:19]
    v_mfma_f32_32x32x16_bf16 v[4:19], v[64:67], v[60:63], v[4:19]
    v_mfma_f32_32x32x16_bf16 v[4:19], v[72:75], v[68:71], v[4:19]
    v_mfma_f32_32x32x16_bf16 v[4:19], v[80:83], v[76:79], v[4:19]
    s_nop 7
    s_nop 3
    s_cmp_eq_u32 s48, 0
    s_cbranch_scc0 p3_xg
    ds_write_b128 v112, v[12:15]
    ds_write_b128 v112, v[16:19] offset:1024
    v_mov_b32 v100, v4
    v_mov_b32 v101, v5
    v_mov_b32 v102, v6
    v_mov_b32 v103, v7
    v_mov_b32 v104, v8
    v_mov_b32 v105, v9
    v_mov_b32 v106, v10
    v_mov_b32 v107, v11
    s_branch p3_xg_e
p3_xg:
    ds_write_b128 v112, v[4:7]
    ds_write_b128 v112, v[8:11] offset:1024
    v_mov_b32 v100, v12
    v_mov_b32 v101, v13
    v_mov_b32 v102, v14
    v_mov_b32 v103, v15
    v_mov_b32 v104, v16
    v_mov_b32 v105, v17
    v_mov_b32 v106, v18
    v_mov_b32 v107, v19
p3_xg_e:
    s_waitcnt vmcnt(0)
    v_lshlrev_b32_e64 v52, 16, v108
    v_and_b32 v53, 0xffff0000, v108
    v_lshlrev_b32_e64 v54, 16, v109
    v_and_b32 v55, 0xffff0000, v109
    v_lshlrev_b32_e64 v56, 16, v110
    v_and_b32 v57, 0xffff0000, v110
    v_lshlrev_b32_e64 v58, 16, v111
    v_and_b32 v59, 0xffff0000, v111
    v_pk_add_f32 v[100:101], v[100:101], v[52:53]
    v_pk_add_f32 v[102:103], v[102:103], v[54:55]
    v_pk_add_f32 v[104:105], v[104:105], v[56:57]
    v_pk_add_f32 v[106:107], v[106:107], v[58:59]
    s_waitcnt lgkmcnt(0)
    s_barrier
    ds_read_b128 v[20:23], v113
    ds_read_b128 v[24:27], v113 offset:1024
    s_waitcnt lgkmcnt(0)
    v_pk_add_f32 v[100:101], v[100:101], v[20:21]
    v_pk_add_f32 v[102:103], v[102:103], v[22:23]
    v_pk_add_f32 v[104:105], v[104:105], v[24:25]
    v_pk_add_f32 v[106:107], v[106:107], v[26:27]
    v_cvt_pk_bf16_f32 v160, v100, v101
    v_cvt_pk_bf16_f32 v161, v102, v103
    v_cvt_pk_bf16_f32 v162, v104, v105
    v_cvt_pk_bf16_f32 v163, v106, v107
    ds_write_b128 v114, v[160:163]
    v_lshlrev_b32 v52, 16, v160
    v_and_b32 v53, 0xffff0000, v160
    v_lshlrev_b32_e64 v54, 16, v161
    v_and_b32 v55, 0xffff0000, v161
    v_lshlrev_b32_e64 v56, 16, v162
    v_and_b32 v57, 0xffff0000, v162
    v_lshlrev_b32_e64 v58, 16, v163
    v_and_b32 v59, 0xffff0000, v163
    v_add_f32 v20, v52, v53
    v_mul_f32 v21, v52, v52
    v_fmac_f32 v21, v53, v53
    v_add_f32 v20, v20, v54
    v_fmac_f32 v21, v54, v54
    v_add_f32 v20, v20, v55
    v_fmac_f32 v21, v55, v55
    v_add_f32 v20, v20, v56
    v_fmac_f32 v21, v56, v56
    v_add_f32 v20, v20, v57
    v_fmac_f32 v21, v57, v57
    v_add_f32 v20, v20, v58
    v_fmac_f32 v21, v58, v58
    v_add_f32 v20, v20, v59
    v_fmac_f32 v21, v59, v59
    v_mov_b32 v96, v20
    s_nop 1
    v_permlane32_swap_b32 v20, v96
    v_add_f32 v20, v20, v96
    v_mov_b32 v96, v21
    s_nop 1
    v_permlane32_swap_b32 v21, v96
    v_add_f32 v21, v21, v96
    v_and_b32 v89, 31, v0
    s_lshl_b32 s40, s51, 9
    s_lshl_b32 s41, s46, 8
    s_add_u32 s40, s40, s41
    s_add_u32 s40, s40, 0
    v_lshl_add_u32 v91, v89, 3, s40
    ds_write_b64 v91, v[20:21]
    s_waitcnt lgkmcnt(0)
    s_barrier
    ds_read_b128 v[20:23], v116
    s_add_u32 s28, s22, 0x700000
    s_addc_u32 s29, s23, 0
    s_mov_b32 s30, 0x200000
    s_mov_b32 s31, 0x20000
    s_add_u32 s32, s22, 0x80000
    s_addc_u32 s33, s23, 0
    s_mov_b32 s34, 0x20000
    s_mov_b32 s35, 0x20000
    s_lshl_b32 s42, s56, 3
    s_add_u32 s42, s42, s57
    s_lshl_b32 s43, s42, 9
    s_lshl_b32 s42, s42, 13
    s_lshl_b32 s40, s3, 10
    s_add_u32 s42, s42, s40
    s_cmp_eq_u32 s3, 0
    s_cbranch_scc0 p3_nostat
    v_lshlrev_b32 v91, 3, v0
    ds_read_b64 v[52:53], v91 offset:0
    ds_read_b64 v[54:55], v91 offset:512
    ds_read_b64 v[56:57], v91 offset:1024
    ds_read_b64 v[58:59], v91 offset:1536
    s_waitcnt lgkmcnt(0)
    v_pk_add_f32 v[52:53], v[52:53], v[54:55]
    v_pk_add_f32 v[56:57], v[56:57], v[58:59]
    v_pk_add_f32 v[52:53], v[52:53], v[56:57]
    s_cmp_eq_u32 s27, 0
    s_cbranch_scc1 tw_11
    buffer_store_dwordx2 v[52:53], v91, s[32:35], s43 offen
tw_11_e:
p3_nostat:
    s_waitcnt lgkmcnt(0)
    s_cmp_eq_u32 s27, 0
    s_cbranch_scc1 tw_12
    buffer_store_dwordx4 v[20:23], v115, s[28:31], s42 offen
tw_12_e:
    s_waitcnt vmcnt(0)
    s_barrier
    s_cmp_eq_u32 s59, 15
    s_cbranch_scc1 C_p5
    s_cmp_ge_u32 s3, 4
    s_cbranch_scc1 C_p4_aux
    s_and_b32 s46, s3, 1
    s_lshr_b32 s47, s3, 1
    v_and_b32 v146, 31, v0
    v_lshrrev_b32 v147, 5, v0
    s_lshl_b32 s48, s46, 1
    v_bfe_u32 v148, v0, 1, 3
    v_xor_b32 v148, v148, v147
    v_lshlrev_b32_e64 v148, 4, v148
    s_lshl_b32 s40, s48, 12
    v_lshl_add_u32 v149, v146, 7, v148
    v_add_u32 v140, s40, v149
    v_xor_b32 v141, 32, v140
    v_xor_b32_e64 v142, 64, v140
    v_xor_b32 v143, 96, v140
    v_bfe_u32 v148, v0, 2, 2
    v_lshl_add_u32 v149, v147, 2, v148
    v_mul_u32_u24 v149, 192, v149
    v_and_b32_e64 v150, 3, v0
    v_lshl_add_u32 v149, v150, 3, v149
    s_mul_i32 s40, s47, 96
    s_add_u32 s40, s40, 90112
    v_add_u32_e64 v149, s40, v149
    v_bfe_u32 v150, v0, 4, 1
    s_cmp_eq_u32 s47, 0
    s_mov_b32 s40, 12256
    s_cmov_b32 s40, 12320
    s_mov_b32 s41, 12320
    s_cmov_b32 s41, 12256
    v_mul_lo_u32 v151, v150, s40
    v_add_u32 v144, v149, v151
    v_mul_lo_u32 v151, v150, s41
    v_add_u32 v145, v149, v151
    s_barrier
    ds_read_b128 v[100:103], v140 offset:0
    ds_read_b128 v[104:107], v140 offset:4096
    ds_read_b64_tr_b16 v[116:117], v144 offset:0
    ds_read_b64_tr_b16 v[118:119], v144 offset:1536
    ds_read_b64_tr_b16 v[120:121], v145 offset:32
    ds_read_b64_tr_b16 v[122:123], v145 offset:1568
    ds_read_b64_tr_b16 v[124:125], v144 offset:64
    ds_read_b64_tr_b16 v[126:127], v144 offset:1600
    s_waitcnt lgkmcnt(4)
    v_mfma_f32_32x32x16_bf16 v[4:19], v[116:119], v[100:103], 0
    ds_read_b128 v[108:111], v141 offset:0
    ds_read_b128 v[112:115], v141 offset:4096
    v_mfma_f32_32x32x16_bf16 v[20:35], v[116:119], v[104:107], 0
    ds_read_b64_tr_b16 v[128:129], v144 offset:3072
    ds_read_b64_tr_b16 v[130:131], v144 offset:4608
    s_waitcnt lgkmcnt(6)
    v_mfma_f32_32x32x16_bf16 v[36:51], v[120:123], v[100:103], 0
    ds_read_b64_tr_b16 v[132:133], v145 offset:3104
    ds_read_b64_tr_b16 v[134:135], v145 offset:4640
    v_mfma_f32_32x32x16_bf16 v[52:67], v[120:123], v[104:107], 0
    s_waitcnt lgkmcnt(6)
    v_mfma_f32_32x32x16_bf16 v[68:83], v[124:127], v[100:103], 0
    ds_read_b64_tr_b16 v[136:137], v144 offset:3136
    ds_read_b64_tr_b16 v[138:139], v144 offset:4672
    v_mfma_f32_32x32x16_bf16 v[84:99], v[124:127], v[104:107], 0
    s_waitcnt lgkmcnt(4)
    v_mfma_f32_32x32x16_bf16 v[4:19], v[128:131], v[108:111], v[4:19]
    ds_read_b128 v[100:103], v142 offset:0
    ds_read_b128 v[104:107], v142 offset:4096
    v_mfma_f32_32x32x16_bf16 v[20:35], v[128:131], v[112:115], v[20:35]
    ds_read_b64_tr_b16 v[116:117], v144 offset:6144
    ds_read_b64_tr_b16 v[118:119], v144 offset:7680
    s_waitcnt lgkmcnt(6)
    v_mfma_f32_32x32x16_bf16 v[36:51], v[132:135], v[108:111], v[36:51]
    ds_read_b64_tr_b16 v[120:121], v145 offset:6176
    ds_read_b64_tr_b16 v[122:123], v145 offset:7712
    v_mfma_f32_32x32x16_bf16 v[52:67], v[132:135], v[112:115], v[52:67]
    s_waitcnt lgkmcnt(6)
    v_mfma_f32_32x32x16_bf16 v[68:83], v[136:139], v[108:111], v[68:83]
    ds_read_b64_tr_b16 v[124:125], v144 offset:6208
    ds_read_b64_tr_b16 v[126:127], v144 offset:7744
    v_mfma_f32_32x32x16_bf16 v[84:99], v[136:139], v[112:115], v[84:99]
    s_waitcnt lgkmcnt(4)
    v_mfma_f32_32x32x16_bf16 v[4:19], v[116:119], v[100:103], v[4:19]
    ds_read_b128 v[108:111], v143 offset:0
    ds_read_b128 v[112:115], v143 offset:4096
    v_mfma_f32_32x32x16_bf16 v[20:35], v[116:119], v[104:107], v[20:35]
    ds_read_b64_tr_b16 v[128:129], v144 offset:9216
    ds_read_b64_tr_b16 v[130:131], v144 offset:10752
    s_waitcnt lgkmcnt(6)
    v_mfma_f32_32x32x16_bf16 v[36:51], v[120:123], v[100:103], v[36:51]
    ds_read_b64_tr_b16 v[132:133], v145 offset:9248
    ds_read_b64_tr_b16 v[134:135], v145 offset:10784
    v_mfma_f32_32x32x16_bf16 v[52:67], v[120:123], v[104:107], v[52:67]
    s_waitcnt lgkmcnt(6)
    v_mfma_f32_32x32x16_bf16 v[68:83], v[124:127], v[100:103], v[68:83]
    ds_read_b64_tr_b16 v[136:137], v144 offset:9280
    ds_read_b64_tr_b16 v[138:139], v144 offset:10816
    v_mfma_f32_32x32x16_bf16 v[84:99], v[124:127], v[104:107], v[84:99]
    s_waitcnt lgkmcnt(0)
    s_barrier
    ds_read_b128 v[100:103], v140 offset:16384
    ds_read_b128 v[104:107], v140 offset:20480
    ds_read_b64_tr_b16 v[116:117], v144 offset:24576
    ds_read_b64_tr_b16 v[118:119], v144 offset:26112
    ds_read_b64_tr_b16 v[120:121], v145 offset:24608
    ds_read_b64_tr_b16 v[122:123], v145 offset:26144
    ds_read_b64_tr_b16 v[124:125], v144 offset:24640
    ds_read_b64_tr_b16 v[126:127], v144 offset:26176
    v_mfma_f32_32x32x16_bf16 v[4:19], v[128:131], v[108:111], v[4:19]
    v_mfma_f32_32x32x16_bf16 v[20:35], v[128:131], v[112:115], v[20:35]
    v_mfma_f32_32x32x16_bf16 v[36:51], v[132:135], v[108:111], v[36:51]
    v_mfma_f32_32x32x16_bf16 v[52:67], v[132:135], v[112:115], v[52:67]
    v_mfma_f32_32x32x16_bf16 v[68:83], v[136:139], v[108:111], v[68:83]
    v_mfma_f32_32x32x16_bf16 v[84:99], v[136:139], v[112:115], v[84:99]
    s_waitcnt lgkmcnt(4)
    v_mfma_f32_32x32x16_bf16 v[4:19], v[116:119], v[100:103], v[4:19]
    ds_read_b128 v[108:111], v141 offset:16384
    ds_read_b128 v[112:115], v141 offset:20480
    v_mfma_f32_32x32x16_bf16 v[20:35], v[116:119], v[104:107], v[20:35]
    ds_read_b64_tr_b16 v[128:129], v144 offset:27648
    ds_read_b64_tr_b16 v[130:131], v144 offset:29184
    s_waitcnt lgkmcnt(6)
    v_mfma_f32_32x32x16_bf16 v[36:51], v[120:123], v[100:103], v[36:51]
    ds_read_b64_tr_b16 v[132:133], v145 offset:27680
    ds_read_b64_tr_b16 v[134:135], v145 offset:29216
    v_mfma_f32_32x32x16_bf16 v[52:67], v[120:123], v[104:107], v[52:67]
    s_waitcnt lgkmcnt(6)
    v_mfma_f32_32x32x16_bf16 v[68:83], v[124:127], v[100:103], v[68:83]
    ds_read_b64_tr_b16 v[136:137], v144 offset:27712
    ds_read_b64_tr_b16 v[138:139], v144 offset:29248
    v_mfma_f32_32x32x16_bf16 v[84:99], v[124:127], v[104:107], v[84:99]
    s_waitcnt lgkmcnt(4)
    v_mfma_f32_32x32x16_bf16 v[4:19], v[128:131], v[108:111], v[4:19]
    ds_read_b128 v[100:103], v142 offset:16384
    ds_read_b128 v[104:107], v142 offset:20480
    v_mfma_f32_32x32x16_bf16 v[20:35], v[128:131], v[112:115], v[20:35]
    ds_read_b64_tr_b16 v[116:117], v144 offset:30720
    ds_read_b64_tr_b16 v[118:119], v144 offset:32256
    s_waitcnt lgkmcnt(6)
    v_mfma_f32_32x32x16_bf16 v[36:51], v[132:135], v[108:111], v[36:51]
    ds_read_b64_tr_b16 v[120:121], v145 offset:30752
    ds_read_b64_tr_b16 v[122:123], v145 offset:32288
    v_mfma_f32_32x32x16_bf16 v[52:67], v[132:135], v[112:115], v[52:67]
    s_waitcnt lgkmcnt(6)
    v_mfma_f32_32x32x16_bf16 v[68:83], v[136:139], v[108:111], v[68:83]
    ds_read_b64_tr_b16 v[124:125], v144 offset:30784
    ds_read_b64_tr_b16 v[126:127], v144 offset:32320
    v_mfma_f32_32x32x16_bf16 v[84:99], v[136:139], v[112:115], v[84:99]
    s_waitcnt lgkmcnt(4)
    v_mfma_f32_32x32x16_bf16 v[4:19], v[116:119], v[100:103], v[4:19]
    ds_read_b128 v[108:111], v143 offset:16384
    ds_read_b128 v[112:115], v143 offset:20480
    v_mfma_f32_32x32x16_bf16 v[20:35], v[116:119], v[104:107], v[20:35]
    ds_read_b64_tr_b16 v[128:129], v144 offset:33792
    ds_read_b64_tr_b16 v[130:131], v144 offset:35328
    s_waitcnt lgkmcnt(6)
    v_mfma_f32_32x32x16_bf16 v[36:51], v[120:123], v[100:103], v[36:51]
    ds_read_b64_tr_b16 v[132:133], v145 offset:33824
    ds_read_b64_tr_b16 v[134:135], v145 offset:35360
    v_mfma_f32_32x32x16_bf16 v[52:67], v[120:123], v[104:107], v[52:67]
    s_waitcnt lgkmcnt(6)
    v_mfma_f32_32x32x16_bf16 v[68:83], v[124:127], v[100:103], v[68:83]
    ds_read_b64_tr_b16 v[136:137], v144 offset:33856
    ds_read_b64_tr_b16 v[138:139], v144 offset:35392
    v_mfma_f32_32x32x16_bf16 v[84:99], v[124:127], v[104:107], v[84:99]
    s_waitcnt lgkmcnt(0)
    s_barrier
    ds_read_b128 v[100:103], v140 offset:32768
    ds_read_b128 v[104:107], v140 offset:36864
    ds_read_b64_tr_b16 v[116:117], v144 offset:49152
    ds_read_b64_tr_b16 v[118:119], v144 offset:50688
    ds_read_b64_tr_b16 v[120:121], v145 offset:49184
    ds_read_b64_tr_b16 v[122:123], v145 offset:50720
    ds_read_b64_tr_b16 v[124:125], v144 offset:49216
    ds_read_b64_tr_b16 v[126:127], v144 offset:50752
    v_mfma_f32_32x32x16_bf16 v[4:19], v[128:131], v[108:111], v[4:19]
    v_mfma_f32_32x32x16_bf16 v[20:35], v[128:131], v[112:115], v[20:35]
    v_mfma_f32_32x32x16_bf16 v[36:51], v[132:135], v[108:111], v[36:51]
    v_mfma_f32_32x32x16_bf16 v[52:67], v[132:135], v[112:115], v[52:67]
    v_mfma_f32_32x32x16_bf16 v[68:83], v[136:139], v[108:111], v[68:83]
    v_mfma_f32_32x32x16_bf16 v[84:99], v[136:139], v[112:115], v[84:99]
    s_waitcnt lgkmcnt(4)
    v_mfma_f32_32x32x16_bf16 v[4:19], v[116:119], v[100:103], v[4:19]
    ds_read_b128 v[108:111], v141 offset:32768
    ds_read_b128 v[112:115], v141 offset:36864
    v_mfma_f32_32x32x16_bf16 v[20:35], v[116:119], v[104:107], v[20:35]
    ds_read_b64_tr_b16 v[128:129], v144 offset:52224
    ds_read_b64_tr_b16 v[130:131], v144 offset:53760
    s_waitcnt lgkmcnt(6)
    v_mfma_f32_32x32x16_bf16 v[36:51], v[120:123], v[100:103], v[36:51]
    ds_read_b64_tr_b16 v[132:133], v145 offset:52256
    ds_read_b64_tr_b16 v[134:135], v145 offset:53792
    v_mfma_f32_32x32x16_bf16 v[52:67], v[120:123], v[104:107], v[52:67]
    s_waitcnt lgkmcnt(6)
    v_mfma_f32_32x32x16_bf16 v[68:83], v[124:127], v[100:103], v[68:83]
    ds_read_b64_tr_b16 v[136:137], v144 offset:52288
    ds_read_b64_tr_b16 v[138:139], v144 offset:53824
    v_mfma_f32_32x32x16_bf16 v[84:99], v[124:127], v[104:107], v[84:99]
    s_waitcnt lgkmcnt(4)
    v_mfma_f32_32x32x16_bf16 v[4:19], v[128:131], v[108:111], v[4:19]
    ds_read_b128 v[100:103], v142 offset:32768
    ds_read_b128 v[104:107], v142 offset:36864
    v_mfma_f32_32x32x16_bf16 v[20:35], v[128:131], v[112:115], v[20:35]
    ds_read_b64_tr_b16 v[116:117], v144 offset:55296
    ds_read_b64_tr_b16 v[118:119], v144 offset:56832
    s_waitcnt lgkmcnt(6)
    v_mfma_f32_32x32x16_bf16 v[36:51], v[132:135], v[108:111], v[36:51]
    ds_read_b64_tr_b16 v[120:121], v145 offset:55328
    ds_read_b64_tr_b16 v[122:123], v145 offset:56864
    v_mfma_f32_32x32x16_bf16 v[52:67], v[132:135], v[112:115], v[52:67]
    s_waitcnt lgkmcnt(6)
    v_mfma_f32_32x32x16_bf16 v[68:83], v[136:139], v[108:111], v[68:83]
    ds_read_b64_tr_b16 v[124:125], v144 offset:55360
    ds_read_b64_tr_b16 v[126:127], v144 offset:56896
    v_mfma_f32_32x32x16_bf16 v[84:99], v[136:139], v[112:115], v[84:99]
    s_waitcnt lgkmcnt(4)
    v_mfma_f32_32x32x16_bf16 v[4:19], v[116:119], v[100:103], v[4:19]
    ds_read_b128 v[108:111], v143 offset:32768
    ds_read_b128 v[112:115], v143 offset:36864
    v_mfma_f32_32x32x16_bf16 v[20:35], v[116:119], v[104:107], v[20:35]
    ds_read_b64_tr_b16 v[128:129], v144 offset:58368
    ds_read_b64_tr_b16 v[130:131], v144 offset:59904
    s_waitcnt lgkmcnt(6)
    v_mfma_f32_32x32x16_bf16 v[36:51], v[120:123], v[100:103], v[36:51]
    ds_read_b64_tr_b16 v[132:133], v145 offset:58400
    ds_read_b64_tr_b16 v[134:135], v145 offset:59936
    v_mfma_f32_32x32x16_bf16 v[52:67], v[120:123], v[104:107], v[52:67]
    s_waitcnt lgkmcnt(6)
    v_mfma_f32_32x32x16_bf16 v[68:83], v[124:127], v[100:103], v[68:83]
    ds_read_b64_tr_b16 v[136:137], v144 offset:58432
    ds_read_b64_tr_b16 v[138:139], v144 offset:59968
    v_mfma_f32_32x32x16_bf16 v[84:99], v[124:127], v[104:107], v[84:99]
    s_waitcnt lgkmcnt(0)
    s_barrier
    ds_read_b128 v[100:103], v140 offset:0
    ds_read_b128 v[104:107], v140 offset:4096
    ds_read_b64_tr_b16 v[116:117], v144 offset:0
    ds_read_b64_tr_b16 v[118:119], v144 offset:1536
    ds_read_b64_tr_b16 v[120:121], v145 offset:32
    ds_read_b64_tr_b16 v[122:123], v145 offset:1568
    ds_read_b64_tr_b16 v[124:125], v144 offset:64
    ds_read_b64_tr_b16 v[126:127], v144 offset:1600
    v_mfma_f32_32x32x16_bf16 v[4:19], v[128:131], v[108:111], v[4:19]
    v_mfma_f32_32x32x16_bf16 v[20:35], v[128:131], v[112:115], v[20:35]
    v_mfma_f32_32x32x16_bf16 v[36:51], v[132:135], v[108:111], v[36:51]
    v_mfma_f32_32x32x16_bf16 v[52:67], v[132:135], v[112:115], v[52:67]
    v_mfma_f32_32x32x16_bf16 v[68:83], v[136:139], v[108:111], v[68:83]
    v_mfma_f32_32x32x16_bf16 v[84:99], v[136:139], v[112:115], v[84:99]
    s_waitcnt lgkmcnt(4)
    v_mfma_f32_32x32x16_bf16 v[4:19], v[116:119], v[100:103], v[4:19]
    ds_read_b128 v[108:111], v141 offset:0
    ds_read_b128 v[112:115], v141 offset:4096
    v_mfma_f32_32x32x16_bf16 v[20:35], v[116:119], v[104:107], v[20:35]
    ds_read_b64_tr_b16 v[128:129], v144 offset:3072
    ds_read_b64_tr_b16 v[130:131], v144 offset:4608
    s_waitcnt lgkmcnt(6)
    v_mfma_f32_32x32x16_bf16 v[36:51], v[120:123], v[100:103], v[36:51]
    ds_read_b64_tr_b16 v[132:133], v145 offset:3104
    ds_read_b64_tr_b16 v[134:135], v145 offset:4640
    v_mfma_f32_32x32x16_bf16 v[52:67], v[120:123], v[104:107], v[52:67]
    s_waitcnt lgkmcnt(6)
    v_mfma_f32_32x32x16_bf16 v[68:83], v[124:127], v[100:103], v[68:83]
    ds_read_b64_tr_b16 v[136:137], v144 offset:3136
    ds_read_b64_tr_b16 v[138:139], v144 offset:4672
    v_mfma_f32_32x32x16_bf16 v[84:99], v[124:127], v[104:107], v[84:99]
    s_waitcnt lgkmcnt(4)
    v_mfma_f32_32x32x16_bf16 v[4:19], v[128:131], v[108:111], v[4:19]
    ds_read_b128 v[100:103], v142 offset:0
    ds_read_b128 v[104:107], v142 offset:4096
    v_mfma_f32_32x32x16_bf16 v[20:35], v[128:131], v[112:115], v[20:35]
    ds_read_b64_tr_b16 v[116:117], v144 offset:6144
    ds_read_b64_tr_b16 v[118:119], v144 offset:7680
    s_waitcnt lgkmcnt(6)
    v_mfma_f32_32x32x16_bf16 v[36:51], v[132:135], v[108:111], v[36:51]
    ds_read_b64_tr_b16 v[120:121], v145 offset:6176
    ds_read_b64_tr_b16 v[122:123], v145 offset:7712
    v_mfma_f32_32x32x16_bf16 v[52:67], v[132:135], v[112:115], v[52:67]
    s_waitcnt lgkmcnt(6)
    v_mfma_f32_32x32x16_bf16 v[68:83], v[136:139], v[108:111], v[68:83]
    ds_read_b64_tr_b16 v[124:125], v144 offset:6208
    ds_read_b64_tr_b16 v[126:127], v144 offset:7744
    v_mfma_f32_32x32x16_bf16 v[84:99], v[136:139], v[112:115], v[84:99]
    s_waitcnt lgkmcnt(4)
    v_mfma_f32_32x32x16_bf16 v[4:19], v[116:119], v[100:103], v[4:19]
    ds_read_b128 v[108:111], v143 offset:0
    ds_read_b128 v[112:115], v143 offset:4096
    v_mfma_f32_32x32x16_bf16 v[20:35], v[116:119], v[104:107], v[20:35]
    ds_read_b64_tr_b16 v[128:129], v144 offset:9216
    ds_read_b64_tr_b16 v[130:131], v144 offset:10752
    s_waitcnt lgkmcnt(6)
    v_mfma_f32_32x32x16_bf16 v[36:51], v[120:123], v[100:103], v[36:51]
    ds_read_b64_tr_b16 v[132:133], v145 offset:9248
    ds_read_b64_tr_b16 v[134:135], v145 offset:10784
    v_mfma_f32_32x32x16_bf16 v[52:67], v[120:123], v[104:107], v[52:67]
    s_waitcnt lgkmcnt(6)
    v_mfma_f32_32x32x16_bf16 v[68:83], v[124:127], v[100:103], v[68:83]
    ds_read_b64_tr_b16 v[136:137], v144 offset:9280
    ds_read_b64_tr_b16 v[138:139], v144 offset:10816
    v_mfma_f32_32x32x16_bf16 v[84:99], v[124:127], v[104:107], v[84:99]
    s_waitcnt lgkmcnt(0)
    s_barrier
    ds_read_b128 v[100:103], v140 offset:16384
    ds_read_b128 v[104:107], v140 offset:20480
    ds_read_b64_tr_b16 v[116:117], v144 offset:24576
    ds_read_b64_tr_b16 v[118:119], v144 offset:26112
    ds_read_b64_tr_b16 v[120:121], v145 offset:24608
    ds_read_b64_tr_b16 v[122:123], v145 offset:26144
    ds_read_b64_tr_b16 v[124:125], v144 offset:24640
    ds_read_b64_tr_b16 v[126:127], v144 offset:26176
    v_mfma_f32_32x32x16_bf16 v[4:19], v[128:131], v[108:111], v[4:19]
    v_mfma_f32_32x32x16_bf16 v[20:35], v[128:131], v[112:115], v[20:35]
    v_mfma_f32_32x32x16_bf16 v[36:51], v[132:135], v[108:111], v[36:51]
    v_mfma_f32_32x32x16_bf16 v[52:67], v[132:135], v[112:115], v[52:67]
    v_mfma_f32_32x32x16_bf16 v[68:83], v[136:139], v[108:111], v[68:83]
    v_mfma_f32_32x32x16_bf16 v[84:99], v[136:139], v[112:115], v[84:99]
    s_waitcnt lgkmcnt(4)
    v_mfma_f32_32x32x16_bf16 v[4:19], v[116:119], v[100:103], v[4:19]
    ds_read_b128 v[108:111], v141 offset:16384
    ds_read_b128 v[112:115], v141 offset:20480
    v_mfma_f32_32x32x16_bf16 v[20:35], v[116:119], v[104:107], v[20:35]
    ds_read_b64_tr_b16 v[128:129], v144 offset:27648
    ds_read_b64_tr_b16 v[130:131], v144 offset:29184
    s_waitcnt lgkmcnt(6)
    v_mfma_f32_32x32x16_bf16 v[36:51], v[120:123], v[100:103], v[36:51]
    ds_read_b64_tr_b16 v[132:133], v145 offset:27680
    ds_read_b64_tr_b16 v[134:135], v145 offset:29216
    v_mfma_f32_32x32x16_bf16 v[52:67], v[120:123], v[104:107], v[52:67]
    s_waitcnt lgkmcnt(6)
    v_mfma_f32_32x32x16_bf16 v[68:83], v[124:127], v[100:103], v[68:83]
    ds_read_b64_tr_b16 v[136:137], v144 offset:27712
    ds_read_b64_tr_b16 v[138:139], v144 offset:29248
    v_mfma_f32_32x32x16_bf16 v[84:99], v[124:127], v[104:107], v[84:99]
    s_waitcnt lgkmcnt(4)
    v_mfma_f32_32x32x16_bf16 v[4:19], v[128:131], v[108:111], v[4:19]
    ds_read_b128 v[100:103], v142 offset:16384
    ds_read_b128 v[104:107], v142 offset:20480
    v_mfma_f32_32x32x16_bf16 v[20:35], v[128:131], v[112:115], v[20:35]
    ds_read_b64_tr_b16 v[116:117], v144 offset:30720
    ds_read_b64_tr_b16 v[118:119], v144 offset:32256
    s_waitcnt lgkmcnt(6)
    v_mfma_f32_32x32x16_bf16 v[36:51], v[132:135], v[108:111], v[36:51]
    ds_read_b64_tr_b16 v[120:121], v145 offset:30752
    ds_read_b64_tr_b16 v[122:123], v145 offset:32288
    v_mfma_f32_32x32x16_bf16 v[52:67], v[132:135], v[112:115], v[52:67]
    s_waitcnt lgkmcnt(6)
    v_mfma_f32_32x32x16_bf16 v[68:83], v[136:139], v[108:111], v[68:83]
    ds_read_b64_tr_b16 v[124:125], v144 offset:30784
    ds_read_b64_tr_b16 v[126:127], v144 offset:32320
    v_mfma_f32_32x32x16_bf16 v[84:99], v[136:139], v[112:115], v[84:99]
    s_waitcnt lgkmcnt(4)
    v_mfma_f32_32x32x16_bf16 v[4:19], v[116:119], v[100:103], v[4:19]
    ds_read_b128 v[108:111], v143 offset:16384
    ds_read_b128 v[112:115], v143 offset:20480
    v_mfma_f32_32x32x16_bf16 v[20:35], v[116:119], v[104:107], v[20:35]
    ds_read_b64_tr_b16 v[128:129], v144 offset:33792
    ds_read_b64_tr_b16 v[130:131], v144 offset:35328
    s_waitcnt lgkmcnt(6)
    v_mfma_f32_32x32x16_bf16 v[36:51], v[120:123], v[100:103], v[36:51]
    ds_read_b64_tr_b16 v[132:133], v145 offset:33824
    ds_read_b64_tr_b16 v[134:135], v145 offset:35360
    v_mfma_f32_32x32x16_bf16 v[52:67], v[120:123], v[104:107], v[52:67]
    s_waitcnt lgkmcnt(6)
    v_mfma_f32_32x32x16_bf16 v[68:83], v[124:127], v[100:103], v[68:83]
    ds_read_b64_tr_b16 v[136:137], v144 offset:33856
    ds_read_b64_tr_b16 v[138:139], v144 offset:35392
    v_mfma_f32_32x32x16_bf16 v[84:99], v[124:127], v[104:107], v[84:99]
    s_waitcnt lgkmcnt(0)
    s_barrier
    ds_read_b128 v[100:103], v140 offset:32768
    ds_read_b128 v[104:107], v140 offset:36864
    ds_read_b64_tr_b16 v[116:117], v144 offset:49152
    ds_read_b64_tr_b16 v[118:119], v144 offset:50688
    ds_read_b64_tr_b16 v[120:121], v145 offset:49184
    ds_read_b64_tr_b16 v[122:123], v145 offset:50720
    ds_read_b64_tr_b16 v[124:125], v144 offset:49216
    ds_read_b64_tr_b16 v[126:127], v144 offset:50752
    v_mfma_f32_32x32x16_bf16 v[4:19], v[128:131], v[108:111], v[4:19]
    v_mfma_f32_32x32x16_bf16 v[20:35], v[128:131], v[112:115], v[20:35]
    v_mfma_f32_32x32x16_bf16 v[36:51], v[132:135], v[108:111], v[36:51]
    v_mfma_f32_32x32x16_bf16 v[52:67], v[132:135], v[112:115], v[52:67]
    v_mfma_f32_32x32x16_bf16 v[68:83], v[136:139], v[108:111], v[68:83]
    v_mfma_f32_32x32x16_bf16 v[84:99], v[136:139], v[112:115], v[84:99]
    s_waitcnt lgkmcnt(4)
    v_mfma_f32_32x32x16_bf16 v[4:19], v[116:119], v[100:103], v[4:19]
    ds_read_b128 v[108:111], v141 offset:32768
    ds_read_b128 v[112:115], v141 offset:36864
    v_mfma_f32_32x32x16_bf16 v[20:35], v[116:119], v[104:107], v[20:35]
    ds_read_b64_tr_b16 v[128:129], v144 offset:52224
    ds_read_b64_tr_b16 v[130:131], v144 offset:53760
    s_waitcnt lgkmcnt(6)
    v_mfma_f32_32x32x16_bf16 v[36:51], v[120:123], v[100:103], v[36:51]
    ds_read_b64_tr_b16 v[132:133], v145 offset:52256
    ds_read_b64_tr_b16 v[134:135], v145 offset:53792
    v_mfma_f32_32x32x16_bf16 v[52:67], v[120:123], v[104:107], v[52:67]
    s_waitcnt lgkmcnt(6)
    v_mfma_f32_32x32x16_bf16 v[68:83], v[124:127], v[100:103], v[68:83]
    ds_read_b64_tr_b16 v[136:137], v144 offset:52288
    ds_read_b64_tr_b16 v[138:139], v144 offset:53824
    v_mfma_f32_32x32x16_bf16 v[84:99], v[124:127], v[104:107], v[84:99]
    s_waitcnt lgkmcnt(4)
    v_mfma_f32_32x32x16_bf16 v[4:19], v[128:131], v[108:111], v[4:19]
    ds_read_b128 v[100:103], v142 offset:32768
    ds_read_b128 v[104:107], v142 offset:36864
    v_mfma_f32_32x32x16_bf16 v[20:35], v[128:131], v[112:115], v[20:35]
    ds_read_b64_tr_b16 v[116:117], v144 offset:55296
    ds_read_b64_tr_b16 v[118:119], v144 offset:56832
    s_waitcnt lgkmcnt(6)
    v_mfma_f32_32x32x16_bf16 v[36:51], v[132:135], v[108:111], v[36:51]
    ds_read_b64_tr_b16 v[120:121], v145 offset:55328
    ds_read_b64_tr_b16 v[122:123], v145 offset:56864
    v_mfma_f32_32x32x16_bf16 v[52:67], v[132:135], v[112:115], v[52:67]
    s_waitcnt lgkmcnt(6)
    v_mfma_f32_32x32x16_bf16 v[68:83], v[136:139], v[108:111], v[68:83]
    ds_read_b64_tr_b16 v[124:125], v144 offset:55360
    ds_read_b64_tr_b16 v[126:127], v144 offset:56896
    v_mfma_f32_32x32x16_bf16 v[84:99], v[136:139], v[112:115], v[84:99]
    s_waitcnt lgkmcnt(4)
    v_mfma_f32_32x32x16_bf16 v[4:19], v[116:119], v[100:103], v[4:19]
    ds_read_b128 v[108:111], v143 offset:32768
    ds_read_b128 v[112:115], v143 offset:36864
    v_mfma_f32_32x32x16_bf16 v[20:35], v[116:119], v[104:107], v[20:35]
    ds_read_b64_tr_b16 v[128:129], v144 offset:58368
    ds_read_b64_tr_b16 v[130:131], v144 offset:59904
    s_waitcnt lgkmcnt(6)
    v_mfma_f32_32x32x16_bf16 v[36:51], v[120:123], v[100:103], v[36:51]
    ds_read_b64_tr_b16 v[132:133], v145 offset:58400
    ds_read_b64_tr_b16 v[134:135], v145 offset:59936
    v_mfma_f32_32x32x16_bf16 v[52:67], v[120:123], v[104:107], v[52:67]
    s_waitcnt lgkmcnt(6)
    v_mfma_f32_32x32x16_bf16 v[68:83], v[124:127], v[100:103], v[68:83]
    ds_read_b64_tr_b16 v[136:137], v144 offset:58432
    ds_read_b64_tr_b16 v[138:139], v144 offset:59968
    v_mfma_f32_32x32x16_bf16 v[84:99], v[124:127], v[104:107], v[84:99]
    s_waitcnt lgkmcnt(0)
    s_barrier
    ds_read_b128 v[100:103], v140 offset:0
    ds_read_b128 v[104:107], v140 offset:4096
    ds_read_b64_tr_b16 v[116:117], v144 offset:0
    ds_read_b64_tr_b16 v[118:119], v144 offset:1536
    ds_read_b64_tr_b16 v[120:121], v145 offset:32
    ds_read_b64_tr_b16 v[122:123], v145 offset:1568
    ds_read_b64_tr_b16 v[124:125], v144 offset:64
    ds_read_b64_tr_b16 v[126:127], v144 offset:1600
    v_mfma_f32_32x32x16_bf16 v[4:19], v[128:131], v[108:111], v[4:19]
    v_mfma_f32_32x32x16_bf16 v[20:35], v[128:131], v[112:115], v[20:35]
    v_mfma_f32_32x32x16_bf16 v[36:51], v[132:135], v[108:111], v[36:51]
    v_mfma_f32_32x32x16_bf16 v[52:67], v[132:135], v[112:115], v[52:67]
    v_mfma_f32_32x32x16_bf16 v[68:83], v[136:139], v[108:111], v[68:83]
    v_mfma_f32_32x32x16_bf16 v[84:99], v[136:139], v[112:115], v[84:99]
    s_waitcnt lgkmcnt(4)
    v_mfma_f32_32x32x16_bf16 v[4:19], v[116:119], v[100:103], v[4:19]
    ds_read_b128 v[108:111], v141 offset:0
    ds_read_b128 v[112:115], v141 offset:4096
    v_mfma_f32_32x32x16_bf16 v[20:35], v[116:119], v[104:107], v[20:35]
    ds_read_b64_tr_b16 v[128:129], v144 offset:3072
    ds_read_b64_tr_b16 v[130:131], v144 offset:4608
    s_waitcnt lgkmcnt(6)
    v_mfma_f32_32x32x16_bf16 v[36:51], v[120:123], v[100:103], v[36:51]
    ds_read_b64_tr_b16 v[132:133], v145 offset:3104
    ds_read_b64_tr_b16 v[134:135], v145 offset:4640
    v_mfma_f32_32x32x16_bf16 v[52:67], v[120:123], v[104:107], v[52:67]
    s_waitcnt lgkmcnt(6)
    v_mfma_f32_32x32x16_bf16 v[68:83], v[124:127], v[100:103], v[68:83]
    ds_read_b64_tr_b16 v[136:137], v144 offset:3136
    ds_read_b64_tr_b16 v[138:139], v144 offset:4672
    v_mfma_f32_32x32x16_bf16 v[84:99], v[124:127], v[104:107], v[84:99]
    s_waitcnt lgkmcnt(4)
    v_mfma_f32_32x32x16_bf16 v[4:19], v[128:131], v[108:111], v[4:19]
    ds_read_b128 v[100:103], v142 offset:0
    ds_read_b128 v[104:107], v142 offset:4096
    v_mfma_f32_32x32x16_bf16 v[20:35], v[128:131], v[112:115], v[20:35]
    ds_read_b64_tr_b16 v[116:117], v144 offset:6144
    ds_read_b64_tr_b16 v[118:119], v144 offset:7680
    s_waitcnt lgkmcnt(6)
    v_mfma_f32_32x32x16_bf16 v[36:51], v[132:135], v[108:111], v[36:51]
    ds_read_b64_tr_b16 v[120:121], v145 offset:6176
    ds_read_b64_tr_b16 v[122:123], v145 offset:7712
    v_mfma_f32_32x32x16_bf16 v[52:67], v[132:135], v[112:115], v[52:67]
    s_waitcnt lgkmcnt(6)
    v_mfma_f32_32x32x16_bf16 v[68:83], v[136:139], v[108:111], v[68:83]
    ds_read_b64_tr_b16 v[124:125], v144 offset:6208
    ds_read_b64_tr_b16 v[126:127], v144 offset:7744
    v_mfma_f32_32x32x16_bf16 v[84:99], v[136:139], v[112:115], v[84:99]
    s_waitcnt lgkmcnt(4)
    v_mfma_f32_32x32x16_bf16 v[4:19], v[116:119], v[100:103], v[4:19]
    ds_read_b128 v[108:111], v143 offset:0
    ds_read_b128 v[112:115], v143 offset:4096
    v_mfma_f32_32x32x16_bf16 v[20:35], v[116:119], v[104:107], v[20:35]
    ds_read_b64_tr_b16 v[128:129], v144 offset:9216
    ds_read_b64_tr_b16 v[130:131], v144 offset:10752
    s_waitcnt lgkmcnt(6)
    v_mfma_f32_32x32x16_bf16 v[36:51], v[120:123], v[100:103], v[36:51]
    ds_read_b64_tr_b16 v[132:133], v145 offset:9248
    ds_read_b64_tr_b16 v[134:135], v145 offset:10784
    v_mfma_f32_32x32x16_bf16 v[52:67], v[120:123], v[104:107], v[52:67]
    s_waitcnt lgkmcnt(6)
    v_mfma_f32_32x32x16_bf16 v[68:83], v[124:127], v[100:103], v[68:83]
    ds_read_b64_tr_b16 v[136:137], v144 offset:9280
    ds_read_b64_tr_b16 v[138:139], v144 offset:10816
    v_mfma_f32_32x32x16_bf16 v[84:99], v[124:127], v[104:107], v[84:99]
    s_waitcnt lgkmcnt(0)
    s_barrier
    ds_read_b128 v[100:103], v140 offset:16384
    ds_read_b128 v[104:107], v140 offset:20480
    ds_read_b64_tr_b16 v[116:117], v144 offset:24576
    ds_read_b64_tr_b16 v[118:119], v144 offset:26112
    ds_read_b64_tr_b16 v[120:121], v145 offset:24608
    ds_read_b64_tr_b16 v[122:123], v145 offset:26144
    ds_read_b64_tr_b16 v[124:125], v144 offset:24640
    ds_read_b64_tr_b16 v[126:127], v144 offset:26176
    v_mfma_f32_32x32x16_bf16 v[4:19], v[128:131], v[108:111], v[4:19]
    v_mfma_f32_32x32x16_bf16 v[20:35], v[128:131], v[112:115], v[20:35]
    v_mfma_f32_32x32x16_bf16 v[36:51], v[132:135], v[108:111], v[36:51]
    v_mfma_f32_32x32x16_bf16 v[52:67], v[132:135], v[112:115], v[52:67]
    v_mfma_f32_32x32x16_bf16 v[68:83], v[136:139], v[108:111], v[68:83]
    v_mfma_f32_32x32x16_bf16 v[84:99], v[136:139], v[112:115], v[84:99]
    s_waitcnt lgkmcnt(4)
    v_mfma_f32_32x32x16_bf16 v[4:19], v[116:119], v[100:103], v[4:19]
    ds_read_b128 v[108:111], v141 offset:16384
    ds_read_b128 v[112:115], v141 offset:20480
    v_mfma_f32_32x32x16_bf16 v[20:35], v[116:119], v[104:107], v[20:35]
    ds_read_b64_tr_b16 v[128:129], v144 offset:27648
    ds_read_b64_tr_b16 v[130:131], v144 offset:29184
    s_waitcnt lgkmcnt(6)
    v_mfma_f32_32x32x16_bf16 v[36:51], v[120:123], v[100:103], v[36:51]
    ds_read_b64_tr_b16 v[132:133], v145 offset:27680
    ds_read_b64_tr_b16 v[134:135], v145 offset:29216
    v_mfma_f32_32x32x16_bf16 v[52:67], v[120:123], v[104:107], v[52:67]
    s_waitcnt lgkmcnt(6)
    v_mfma_f32_32x32x16_bf16 v[68:83], v[124:127], v[100:103], v[68:83]
    ds_read_b64_tr_b16 v[136:137], v144 offset:27712
    ds_read_b64_tr_b16 v[138:139], v144 offset:29248
    v_mfma_f32_32x32x16_bf16 v[84:99], v[124:127], v[104:107], v[84:99]
    s_waitcnt lgkmcnt(4)
    v_mfma_f32_32x32x16_bf16 v[4:19], v[128:131], v[108:111], v[4:19]
    ds_read_b128 v[100:103], v142 offset:16384
    ds_read_b128 v[104:107], v142 offset:20480
    v_mfma_f32_32x32x16_bf16 v[20:35], v[128:131], v[112:115], v[20:35]
    ds_read_b64_tr_b16 v[116:117], v144 offset:30720
    ds_read_b64_tr_b16 v[118:119], v144 offset:32256
    s_waitcnt lgkmcnt(6)
    v_mfma_f32_32x32x16_bf16 v[36:51], v[132:135], v[108:111], v[36:51]
    ds_read_b64_tr_b16 v[120:121], v145 offset:30752
    ds_read_b64_tr_b16 v[122:123], v145 offset:32288
    v_mfma_f32_32x32x16_bf16 v[52:67], v[132:135], v[112:115], v[52:67]
    s_waitcnt lgkmcnt(6)
    v_mfma_f32_32x32x16_bf16 v[68:83], v[136:139], v[108:111], v[68:83]
    ds_read_b64_tr_b16 v[124:125], v144 offset:30784
    ds_read_b64_tr_b16 v[126:127], v144 offset:32320
    v_mfma_f32_32x32x16_bf16 v[84:99], v[136:139], v[112:115], v[84:99]
    s_waitcnt lgkmcnt(4)
    v_mfma_f32_32x32x16_bf16 v[4:19], v[116:119], v[100:103], v[4:19]
    ds_read_b128 v[108:111], v143 offset:16384
    ds_read_b128 v[112:115], v143 offset:20480
    v_mfma_f32_32x32x16_bf16 v[20:35], v[116:119], v[104:107], v[20:35]
    ds_read_b64_tr_b16 v[128:129], v144 offset:33792
    ds_read_b64_tr_b16 v[130:131], v144 offset:35328
    s_waitcnt lgkmcnt(6)
    v_mfma_f32_32x32x16_bf16 v[36:51], v[120:123], v[100:103], v[36:51]
    ds_read_b64_tr_b16 v[132:133], v145 offset:33824
    ds_read_b64_tr_b16 v[134:135], v145 offset:35360
    v_mfma_f32_32x32x16_bf16 v[52:67], v[120:123], v[104:107], v[52:67]
    s_waitcnt lgkmcnt(6)
    v_mfma_f32_32x32x16_bf16 v[68:83], v[124:127], v[100:103], v[68:83]
    ds_read_b64_tr_b16 v[136:137], v144 offset:33856
    ds_read_b64_tr_b16 v[138:139], v144 offset:35392
    v_mfma_f32_32x32x16_bf16 v[84:99], v[124:127], v[104:107], v[84:99]
    s_waitcnt lgkmcnt(0)
    v_mfma_f32_32x32x16_bf16 v[4:19], v[128:131], v[108:111], v[4:19]
    v_mfma_f32_32x32x16_bf16 v[20:35], v[128:131], v[112:115], v[20:35]
    v_mfma_f32_32x32x16_bf16 v[36:51], v[132:135], v[108:111], v[36:51]
    v_mfma_f32_32x32x16_bf16 v[52:67], v[132:135], v[112:115], v[52:67]
    v_mfma_f32_32x32x16_bf16 v[68:83], v[136:139], v[108:111], v[68:83]
    v_mfma_f32_32x32x16_bf16 v[84:99], v[136:139], v[112:115], v[84:99]
    v_and_b32 v146, 31, v0
    v_lshrrev_b32 v147, 5, v0
    s_lshl_b32 s40, s46, 9
    s_add_u32 s40, s40, 75776
    v_lshl_add_u32 v148, v146, 3, s40
    s_mul_i32 s40, s47, 768
    s_add_u32 s40, s40, 73728
    v_lshl_add_u32 v149, v146, 2, s40
    v_bfe_u32 v140, v0, 2, 2
    v_xor_b32 v140, v140, v147
    v_lshlrev_b32 v140, 4, v140
    v_lshl_add_u32 v150, v146, 6, v140
    v_xor_b32 v151, 32, v150
    s_mul_i32 s40, s46, 12288
    s_add_u32 s40, s40, 49152
    s_lshl_b32 s41, s47, 12
    s_add_u32 s40, s40, s41
    v_add_u32 v150, s40, v150
    s_lshl_b32 s41, s47, 5
    v_xor_b32 v150, s41, v150
    v_xor_b32 v151, 32, v150
    s_lshl_b32 s41, s47, 12
    v_add_u32 v151, s41, v151
    s_mov_b32 s62, -1
    s_mov_b32 s63, 0
    s_barrier
    ds_read_b64 v[100:101], v148 offset:0
    ds_read_b64 v[102:103], v148 offset:256
    ds_read_b32 v104, v149 offset:0
    ds_read_b32 v105, v149 offset:384
    ds_read_b32 v106, v149 offset:128
    ds_read_b32 v107, v149 offset:512
    ds_read_b32 v108, v149 offset:256
    ds_read_b32 v109, v149 offset:640
    s_waitcnt lgkmcnt(0)
    v_add_f32 v104, v104, v105
    v_add_f32 v106, v106, v107
    v_add_f32 v108, v108, v109
    v_cvt_pk_bf16_f32 v146, v100, v100
    v_lshlrev_b32 v146, 16, v146
    v_sub_f32 v147, v100, v146
    v_cvt_pk_bf16_f32 v124, v146, v146
    v_cvt_pk_bf16_f32 v125, v147, 0
    v_mov_b32 v126, 0
    v_mov_b32 v127, 0
    v_cvt_pk_bf16_f32 v146, v102, v102
    v_lshlrev_b32 v146, 16, v146
    v_sub_f32 v147, v102, v146
    v_cvt_pk_bf16_f32 v128, v146, v146
    v_cvt_pk_bf16_f32 v129, v147, 0
    v_mov_b32 v130, 0
    v_mov_b32 v131, 0
    v_cndmask_b32_e64 v104, 0, v104, s[62:63]
    v_cvt_pk_bf16_f32 v132, v104, v104
    v_lshlrev_b32 v132, 16, v132
    v_sub_f32 v133, v104, v132
    v_cvt_pk_bf16_f32 v112, v132, v133
    v_cvt_pk_bf16_f32 v113, v132, 0
    v_mov_b32 v114, 0
    v_mov_b32_e64 v115, 0
    s_nop 1
    v_mfma_f32_32x32x16_bf16 v[4:19], v[112:115], v[124:127], v[4:19]
    v_mfma_f32_32x32x16_bf16 v[20:35], v[112:115], v[128:131], v[20:35]
    v_cndmask_b32_e64 v106, 0, v106, s[62:63]
    v_cvt_pk_bf16_f32 v132, v106, v106
    v_lshlrev_b32 v132, 16, v132
    v_sub_f32 v133, v106, v132
    v_cvt_pk_bf16_f32 v116, v132, v133
    v_cvt_pk_bf16_f32 v117, v132, 0
    v_mov_b32 v118, 0
    v_mov_b32_e64 v119, 0
    s_nop 1
    v_mfma_f32_32x32x16_bf16 v[36:51], v[116:119], v[124:127], v[36:51]
    v_mfma_f32_32x32x16_bf16 v[52:67], v[116:119], v[128:131], v[52:67]
    v_cndmask_b32_e64 v108, 0, v108, s[62:63]
    v_cvt_pk_bf16_f32 v132, v108, v108
    v_lshlrev_b32 v132, 16, v132
    v_sub_f32 v133, v108, v132
    v_cvt_pk_bf16_f32 v120, v132, v133
    v_cvt_pk_bf16_f32 v121, v132, 0
    v_mov_b32 v122, 0
    v_mov_b32_e64 v123, 0
    s_nop 1
    v_mfma_f32_32x32x16_bf16 v[68:83], v[120:123], v[124:127], v[68:83]
    v_mfma_f32_32x32x16_bf16 v[84:99], v[120:123], v[128:131], v[84:99]
    s_nop 7
    v_mul_f32 v152, 0xc0135761, v101
    v_mul_f32 v108, v101, v101
    v_rcp_f32 v112, v108
    v_mul_f32 v108, v108, v101
    v_mul_f32 v108, 0xbdd2d3e8, v108
    v_mul_f32 v154, 0xc0135761, v103
    v_mul_f32 v110, v103, v103
    v_rcp_f32 v114, v110
    v_mul_f32_e64 v110, v110, v103
    v_mul_f32 v110, 0xbdd2d3e8, v110
    v_pk_mul_f32 v[132:133], v[4:5], v[4:5]
    v_pk_mul_f32 v[134:135], v[6:7], v[6:7]
    v_pk_mul_f32 v[136:137], v[8:9], v[8:9]
    v_pk_mul_f32 v[138:139], v[10:11], v[10:11]
    v_pk_fma_f32 v[132:133], v[132:133], v[108:109], v[152:153] op_sel_hi:[1,0,0]
    v_pk_fma_f32 v[134:135], v[134:135], v[108:109], v[152:153] op_sel_hi:[1,0,0]
    v_pk_fma_f32 v[136:137], v[136:137], v[108:109], v[152:153] op_sel_hi:[1,0,0]
    v_pk_fma_f32 v[138:139], v[138:139], v[108:109], v[152:153] op_sel_hi:[1,0,0]
    v_pk_mul_f32 v[132:133], v[132:133], v[4:5]
    v_pk_mul_f32 v[134:135], v[134:135], v[6:7]
    v_pk_mul_f32 v[136:137], v[136:137], v[8:9]
    v_pk_mul_f32 v[138:139], v[138:139], v[10:11]
    v_exp_f32 v132, v132
    v_exp_f32 v133, v133
    v_pk_mul_f32 v[140:141], v[4:5], v[12:13]
    v_exp_f32 v134, v134
    v_exp_f32 v135, v135
    v_pk_mul_f32 v[142:143], v[6:7], v[14:15]
    v_exp_f32 v136, v136
    v_exp_f32 v137, v137
    v_pk_mul_f32 v[144:145], v[8:9], v[16:17]
    v_exp_f32 v138, v138
    v_exp_f32 v139, v139
    v_pk_mul_f32 v[146:147], v[10:11], v[18:19]
    v_pk_fma_f32 v[132:133], v[132:133], v[112:113], v[112:113] op_sel_hi:[1,0,0]
    v_pk_fma_f32 v[134:135], v[134:135], v[112:113], v[112:113] op_sel_hi:[1,0,0]
    v_pk_fma_f32 v[136:137], v[136:137], v[112:113], v[112:113] op_sel_hi:[1,0,0]
    v_pk_fma_f32 v[138:139], v[138:139], v[112:113], v[112:113] op_sel_hi:[1,0,0]
    v_rcp_f32 v132, v132
    v_rcp_f32 v133, v133
    v_rcp_f32 v134, v134
    v_rcp_f32 v135, v135
    v_rcp_f32 v136, v136
    v_rcp_f32 v137, v137
    v_rcp_f32 v138, v138
    v_rcp_f32_e64 v139, v139
    s_nop 0
    v_pk_mul_f32 v[140:141], v[140:141], v[132:133]
    v_pk_mul_f32 v[142:143], v[142:143], v[134:135]
    v_pk_mul_f32 v[144:145], v[144:145], v[136:137]
    v_pk_mul_f32 v[146:147], v[146:147], v[138:139]
    v_cvt_pk_bf16_f32 v104, v140, v141
    v_cvt_pk_bf16_f32 v105, v142, v143
    v_cvt_pk_bf16_f32 v106, v144, v145
    v_cvt_pk_bf16_f32 v107, v146, v147
    ds_write_b128 v150, v[104:107] offset:0
    s_nop 1
    v_pk_mul_f32 v[132:133], v[20:21], v[20:21]
    v_pk_mul_f32 v[134:135], v[22:23], v[22:23]
    v_pk_mul_f32 v[136:137], v[24:25], v[24:25]
    v_pk_mul_f32 v[138:139], v[26:27], v[26:27]
    v_pk_fma_f32 v[132:133], v[132:133], v[110:111], v[154:155] op_sel_hi:[1,0,0]
    v_pk_fma_f32 v[134:135], v[134:135], v[110:111], v[154:155] op_sel_hi:[1,0,0]
    v_pk_fma_f32 v[136:137], v[136:137], v[110:111], v[154:155] op_sel_hi:[1,0,0]
    v_pk_fma_f32 v[138:139], v[138:139], v[110:111], v[154:155] op_sel_hi:[1,0,0]
    v_pk_mul_f32 v[132:133], v[132:133], v[20:21]
    v_pk_mul_f32 v[134:135], v[134:135], v[22:23]
    v_pk_mul_f32 v[136:137], v[136:137], v[24:25]
    v_pk_mul_f32 v[138:139], v[138:139], v[26:27]
    v_exp_f32 v132, v132
    v_exp_f32_e64 v133, v133
    v_pk_mul_f32 v[140:141], v[20:21], v[28:29]
    v_exp_f32 v134, v134
    v_exp_f32 v135, v135
    v_pk_mul_f32 v[142:143], v[22:23], v[30:31]
    v_exp_f32 v136, v136
    v_exp_f32 v137, v137
    v_pk_mul_f32 v[144:145], v[24:25], v[32:33]
    v_exp_f32 v138, v138
    v_exp_f32 v139, v139
    v_pk_mul_f32 v[146:147], v[26:27], v[34:35]
    v_pk_fma_f32 v[132:133], v[132:133], v[114:115], v[114:115] op_sel_hi:[1,0,0]
    v_pk_fma_f32 v[134:135], v[134:135], v[114:115], v[114:115] op_sel_hi:[1,0,0]
    v_pk_fma_f32 v[136:137], v[136:137], v[114:115], v[114:115] op_sel_hi:[1,0,0]
    v_pk_fma_f32 v[138:139], v[138:139], v[114:115], v[114:115] op_sel_hi:[1,0,0]
    v_rcp_f32 v132, v132
    v_rcp_f32 v133, v133
    v_rcp_f32 v134, v134
    v_rcp_f32 v135, v135
    v_rcp_f32 v136, v136
    v_rcp_f32 v137, v137
    v_rcp_f32 v138, v138
    v_rcp_f32_e64 v139, v139
    s_nop 0
    v_pk_mul_f32 v[140:141], v[140:141], v[132:133]
    v_pk_mul_f32 v[142:143], v[142:143], v[134:135]
    v_pk_mul_f32 v[144:145], v[144:145], v[136:137]
    v_pk_mul_f32 v[146:147], v[146:147], v[138:139]
    v_cvt_pk_bf16_f32 v104, v140, v141
    v_cvt_pk_bf16_f32 v105, v142, v143
    v_cvt_pk_bf16_f32 v106, v144, v145
    v_cvt_pk_bf16_f32 v107, v146, v147
    ds_write_b128 v150, v[104:107] offset:2048
    s_nop 1
    v_pk_mul_f32 v[132:133], v[36:37], v[36:37]
    v_pk_mul_f32 v[134:135], v[38:39], v[38:39]
    v_pk_mul_f32 v[136:137], v[40:41], v[40:41]
    v_pk_mul_f32 v[138:139], v[42:43], v[42:43]
    v_pk_fma_f32 v[132:133], v[132:133], v[108:109], v[152:153] op_sel_hi:[1,0,0]
    v_pk_fma_f32 v[134:135], v[134:135], v[108:109], v[152:153] op_sel_hi:[1,0,0]
    v_pk_fma_f32 v[136:137], v[136:137], v[108:109], v[152:153] op_sel_hi:[1,0,0]
    v_pk_fma_f32 v[138:139], v[138:139], v[108:109], v[152:153] op_sel_hi:[1,0,0]
    v_pk_mul_f32 v[132:133], v[132:133], v[36:37]
    v_pk_mul_f32 v[134:135], v[134:135], v[38:39]
    v_pk_mul_f32 v[136:137], v[136:137], v[40:41]
    v_pk_mul_f32 v[138:139], v[138:139], v[42:43]
    v_exp_f32 v132, v132
    v_exp_f32_e64 v133, v133
    v_pk_mul_f32 v[140:141], v[36:37], v[44:45]
    v_exp_f32 v134, v134
    v_exp_f32 v135, v135
    v_pk_mul_f32 v[142:143], v[38:39], v[46:47]
    v_exp_f32 v136, v136
    v_exp_f32 v137, v137
    v_pk_mul_f32 v[144:145], v[40:41], v[48:49]
    v_exp_f32 v138, v138
    v_exp_f32 v139, v139
    v_pk_mul_f32 v[146:147], v[42:43], v[50:51]
    v_pk_fma_f32 v[132:133], v[132:133], v[112:113], v[112:113] op_sel_hi:[1,0,0]
    v_pk_fma_f32 v[134:135], v[134:135], v[112:113], v[112:113] op_sel_hi:[1,0,0]
    v_pk_fma_f32 v[136:137], v[136:137], v[112:113], v[112:113] op_sel_hi:[1,0,0]
    v_pk_fma_f32 v[138:139], v[138:139], v[112:113], v[112:113] op_sel_hi:[1,0,0]
    v_rcp_f32 v132, v132
    v_rcp_f32 v133, v133
    v_rcp_f32 v134, v134
    v_rcp_f32 v135, v135
    v_rcp_f32 v136, v136
    v_rcp_f32 v137, v137
    v_rcp_f32 v138, v138
    v_rcp_f32_e64 v139, v139
    s_nop 0
    v_pk_mul_f32 v[140:141], v[140:141], v[132:133]
    v_pk_mul_f32 v[142:143], v[142:143], v[134:135]
    v_pk_mul_f32 v[144:145], v[144:145], v[136:137]
    v_pk_mul_f32 v[146:147], v[146:147], v[138:139]
    v_cvt_pk_bf16_f32 v104, v140, v141
    v_cvt_pk_bf16_f32 v105, v142, v143
    v_cvt_pk_bf16_f32 v106, v144, v145
    v_cvt_pk_bf16_f32 v107, v146, v147
    ds_write_b128 v151, v[104:107] offset:0
    s_nop 1
    v_pk_mul_f32 v[132:133], v[52:53], v[52:53]
    v_pk_mul_f32 v[134:135], v[54:55], v[54:55]
    v_pk_mul_f32 v[136:137], v[56:57], v[56:57]
    v_pk_mul_f32 v[138:139], v[58:59], v[58:59]
    v_pk_fma_f32 v[132:133], v[132:133], v[110:111], v[154:155] op_sel_hi:[1,0,0]
    v_pk_fma_f32 v[134:135], v[134:135], v[110:111], v[154:155] op_sel_hi:[1,0,0]
    v_pk_fma_f32 v[136:137], v[136:137], v[110:111], v[154:155] op_sel_hi:[1,0,0]
    v_pk_fma_f32 v[138:139], v[138:139], v[110:111], v[154:155] op_sel_hi:[1,0,0]
    v_pk_mul_f32 v[132:133], v[132:133], v[52:53]
    v_pk_mul_f32 v[134:135], v[134:135], v[54:55]
    v_pk_mul_f32 v[136:137], v[136:137], v[56:57]
    v_pk_mul_f32 v[138:139], v[138:139], v[58:59]
    v_exp_f32 v132, v132
    v_exp_f32_e64 v133, v133
    v_pk_mul_f32 v[140:141], v[52:53], v[60:61]
    v_exp_f32 v134, v134
    v_exp_f32 v135, v135
    v_pk_mul_f32 v[142:143], v[54:55], v[62:63]
    v_exp_f32 v136, v136
    v_exp_f32 v137, v137
    v_pk_mul_f32 v[144:145], v[56:57], v[64:65]
    v_exp_f32 v138, v138
    v_exp_f32 v139, v139
    v_pk_mul_f32 v[146:147], v[58:59], v[66:67]
    v_pk_fma_f32 v[132:133], v[132:133], v[114:115], v[114:115] op_sel_hi:[1,0,0]
    v_pk_fma_f32 v[134:135], v[134:135], v[114:115], v[114:115] op_sel_hi:[1,0,0]
    v_pk_fma_f32 v[136:137], v[136:137], v[114:115], v[114:115] op_sel_hi:[1,0,0]
    v_pk_fma_f32 v[138:139], v[138:139], v[114:115], v[114:115] op_sel_hi:[1,0,0]
    v_rcp_f32 v132, v132
    v_rcp_f32 v133, v133
    v_rcp_f32 v134, v134
    v_rcp_f32 v135, v135
    v_rcp_f32 v136, v136
    v_rcp_f32 v137, v137
    v_rcp_f32 v138, v138
    v_rcp_f32_e64 v139, v139
    s_nop 0
    v_pk_mul_f32 v[140:141], v[140:141], v[132:133]
    v_pk_mul_f32 v[142:143], v[142:143], v[134:135]
    v_pk_mul_f32 v[144:145], v[144:145], v[136:137]
    v_pk_mul_f32 v[146:147], v[146:147], v[138:139]
    v_cvt_pk_bf16_f32 v104, v140, v141
    v_cvt_pk_bf16_f32 v105, v142, v143
    v_cvt_pk_bf16_f32 v106, v144, v145
    v_cvt_pk_bf16_f32 v107, v146, v147
    ds_write_b128 v151, v[104:107] offset:2048
    s_nop 1
    v_pk_mul_f32 v[132:133], v[68:69], v[68:69]
    v_pk_mul_f32 v[134:135], v[70:71], v[70:71]
    v_pk_mul_f32 v[136:137], v[72:73], v[72:73]
    v_pk_mul_f32 v[138:139], v[74:75], v[74:75]
    v_pk_fma_f32 v[132:133], v[132:133], v[108:109], v[152:153] op_sel_hi:[1,0,0]
    v_pk_fma_f32 v[134:135], v[134:135], v[108:109], v[152:153] op_sel_hi:[1,0,0]
    v_pk_fma_f32 v[136:137], v[136:137], v[108:109], v[152:153] op_sel_hi:[1,0,0]
    v_pk_fma_f32 v[138:139], v[138:139], v[108:109], v[152:153] op_sel_hi:[1,0,0]
    v_pk_mul_f32 v[132:133], v[132:133], v[68:69]
    v_pk_mul_f32 v[134:135], v[134:135], v[70:71]
    v_pk_mul_f32 v[136:137], v[136:137], v[72:73]
    v_pk_mul_f32 v[138:139], v[138:139], v[74:75]
    v_exp_f32 v132, v132
    v_exp_f32_e64 v133, v133
    v_pk_mul_f32 v[140:141], v[68:69], v[76:77]
    v_exp_f32 v134, v134
    v_exp_f32 v135, v135
    v_pk_mul_f32 v[142:143], v[70:71], v[78:79]
    v_exp_f32 v136, v136
    v_exp_f32 v137, v137
    v_pk_mul_f32 v[144:145], v[72:73], v[80:81]
    v_exp_f32 v138, v138
    v_exp_f32 v139, v139
    v_pk_mul_f32 v[146:147], v[74:75], v[82:83]
    v_pk_fma_f32 v[132:133], v[132:133], v[112:113], v[112:113] op_sel_hi:[1,0,0]
    v_pk_fma_f32 v[134:135], v[134:135], v[112:113], v[112:113] op_sel_hi:[1,0,0]
    v_pk_fma_f32 v[136:137], v[136:137], v[112:113], v[112:113] op_sel_hi:[1,0,0]
    v_pk_fma_f32 v[138:139], v[138:139], v[112:113], v[112:113] op_sel_hi:[1,0,0]
    v_rcp_f32 v132, v132
    v_rcp_f32 v133, v133
    v_rcp_f32 v134, v134
    v_rcp_f32 v135, v135
    v_rcp_f32 v136, v136
    v_rcp_f32 v137, v137
    v_rcp_f32 v138, v138
    v_rcp_f32_e64 v139, v139
    s_nop 0
    v_pk_mul_f32 v[140:141], v[140:141], v[132:133]
    v_pk_mul_f32 v[142:143], v[142:143], v[134:135]
    v_pk_mul_f32 v[144:145], v[144:145], v[136:137]
    v_pk_mul_f32 v[146:147], v[146:147], v[138:139]
    v_cvt_pk_bf16_f32 v104, v140, v141
    v_cvt_pk_bf16_f32 v105, v142, v143
    v_cvt_pk_bf16_f32 v106, v144, v145
    v_cvt_pk_bf16_f32 v107, v146, v147
    ds_write_b128 v150, v[104:107] offset:4096
    s_nop 1
    v_pk_mul_f32 v[132:133], v[84:85], v[84:85]
    v_pk_mul_f32 v[134:135], v[86:87], v[86:87]
    v_pk_mul_f32 v[136:137], v[88:89], v[88:89]
    v_pk_mul_f32 v[138:139], v[90:91], v[90:91]
    v_pk_fma_f32 v[132:133], v[132:133], v[110:111], v[154:155] op_sel_hi:[1,0,0]
    v_pk_fma_f32 v[134:135], v[134:135], v[110:111], v[154:155] op_sel_hi:[1,0,0]
    v_pk_fma_f32 v[136:137], v[136:137], v[110:111], v[154:155] op_sel_hi:[1,0,0]
    v_pk_fma_f32 v[138:139], v[138:139], v[110:111], v[154:155] op_sel_hi:[1,0,0]
    v_pk_mul_f32 v[132:133], v[132:133], v[84:85]
    v_pk_mul_f32 v[134:135], v[134:135], v[86:87]
    v_pk_mul_f32 v[136:137], v[136:137], v[88:89]
    v_pk_mul_f32 v[138:139], v[138:139], v[90:91]
    v_exp_f32 v132, v132
    v_exp_f32_e64 v133, v133
    v_pk_mul_f32 v[140:141], v[84:85], v[92:93]
    v_exp_f32 v134, v134
    v_exp_f32 v135, v135
    v_pk_mul_f32 v[142:143], v[86:87], v[94:95]
    v_exp_f32 v136, v136
    v_exp_f32 v137, v137
    v_pk_mul_f32 v[144:145], v[88:89], v[96:97]
    v_exp_f32 v138, v138
    v_exp_f32 v139, v139
    v_pk_mul_f32 v[146:147], v[90:91], v[98:99]
    v_pk_fma_f32 v[132:133], v[132:133], v[114:115], v[114:115] op_sel_hi:[1,0,0]
    v_pk_fma_f32 v[134:135], v[134:135], v[114:115], v[114:115] op_sel_hi:[1,0,0]
    v_pk_fma_f32 v[136:137], v[136:137], v[114:115], v[114:115] op_sel_hi:[1,0,0]
    v_pk_fma_f32 v[138:139], v[138:139], v[114:115], v[114:115] op_sel_hi:[1,0,0]
    v_rcp_f32 v132, v132
    v_rcp_f32 v133, v133
    v_rcp_f32 v134, v134
    v_rcp_f32 v135, v135
    v_rcp_f32 v136, v136
    v_rcp_f32 v137, v137
    v_rcp_f32 v138, v138
    v_rcp_f32_e64 v139, v139
    s_nop 0
    v_pk_mul_f32 v[140:141], v[140:141], v[132:133]
    v_pk_mul_f32 v[142:143], v[142:143], v[134:135]
    v_pk_mul_f32 v[144:145], v[144:145], v[136:137]
    v_pk_mul_f32 v[146:147], v[146:147], v[138:139]
    v_cvt_pk_bf16_f32 v104, v140, v141
    v_cvt_pk_bf16_f32 v105, v142, v143
    v_cvt_pk_bf16_f32 v106, v144, v145
    v_cvt_pk_bf16_f32 v107, v146, v147
    ds_write_b128 v150, v[104:107] offset:6144
    s_nop 1
    s_branch C_p4_out
C_p4_aux:
    s_sub_u32 s46, s3, 4
    s_lshr_b32 s47, s46, 1
    s_and_b32 s48, s46, 1
    v_and_b32 v56, 31, v0
    v_lshrrev_b32_e64 v57, 5, v0
    v_bfe_u32 v58, v0, 2, 2
    v_lshl_add_u32 v59, v57, 2, v58
    v_mul_u32_u24 v59, 192, v59
    v_and_b32_e64 v60, 3, v0
    v_lshl_add_u32 v59, v60, 3, v59
    s_mul_i32 s40, s47, 96
    s_add_u32 s40, s40, 90112
    v_add_u32_e64 v59, s40, v59
    v_bfe_u32 v60, v0, 4, 1
    s_cmp_eq_u32 s47, 0
    s_mov_b32 s40, 12256
    s_cmov_b32 s40, 12320
    s_mov_b32 s41, 12320
    s_cmov_b32 s41, 12256
    v_mul_lo_u32 v61, v60, s40
    v_add_u32 v44, v59, v61
    v_mul_lo_u32 v61, v60, s41
    v_add_u32 v45, v59, v61
    s_mul_i32 s40, s48, 6144
    v_add_u32 v44, s40, v44
    v_add_u32 v45, s40, v45
    v_mov_b32 v46, 0
    v_mov_b32 v47, 0
    v_mov_b32 v48, 0
    v_mov_b32 v49, 0
    v_mov_b32 v50, 0
    v_mov_b32 v51, 0
    s_add_u32 s28, s22, 0x80000
    s_addc_u32 s29, s23, 0
    s_mov_b32 s30, 0x20000
    s_mov_b32 s31, 0x20000
    s_lshl_b32 s50, s58, 1
    s_lshr_b32 s40, s46, 1
    s_add_u32 s50, s50, s40
    s_lshl_b32 s50, s50, 12
    s_and_b32 s40, s46, 1
    s_lshl_b32 s40, s40, 8
    s_add_u32 s50, s50, s40
    v_lshlrev_b32 v62, 3, v56
    s_barrier
    ds_read_b64_tr_b16 v[4:5], v44 offset:0
    ds_read_b64_tr_b16 v[6:7], v44 offset:1536
    ds_read_b64_tr_b16 v[8:9], v45 offset:32
    ds_read_b64_tr_b16 v[10:11], v45 offset:1568
    ds_read_b64_tr_b16 v[12:13], v44 offset:64
    ds_read_b64_tr_b16 v[14:15], v44 offset:1600
    ds_read_b64_tr_b16 v[16:17], v44 offset:3072
    ds_read_b64_tr_b16 v[18:19], v44 offset:4608
    ds_read_b64_tr_b16 v[20:21], v45 offset:3104
    ds_read_b64_tr_b16 v[22:23], v45 offset:4640
    ds_read_b64_tr_b16 v[24:25], v44 offset:3136
    ds_read_b64_tr_b16 v[26:27], v44 offset:4672
    s_waitcnt lgkmcnt(6)
    v_lshlrev_b32_e64 v52, 16, v4
    v_and_b32 v53, 0xffff0000, v4
    v_add_f32 v46, v46, v52
    v_add_f32 v49, v49, v53
    v_lshlrev_b32_e64 v54, 16, v5
    v_and_b32 v55, 0xffff0000, v5
    v_add_f32 v46, v46, v54
    v_add_f32 v49, v49, v55
    v_lshlrev_b32_e64 v52, 16, v6
    v_and_b32 v53, 0xffff0000, v6
    v_add_f32 v46, v46, v52
    v_add_f32 v49, v49, v53
    v_lshlrev_b32_e64 v54, 16, v7
    v_and_b32 v55, 0xffff0000, v7
    v_add_f32 v46, v46, v54
    v_add_f32 v49, v49, v55
    v_lshlrev_b32_e64 v52, 16, v8
    v_and_b32 v53, 0xffff0000, v8
    v_add_f32 v47, v47, v52
    v_add_f32 v50, v50, v53
    v_lshlrev_b32_e64 v54, 16, v9
    v_and_b32 v55, 0xffff0000, v9
    v_add_f32 v47, v47, v54
    v_add_f32 v50, v50, v55
    v_lshlrev_b32_e64 v52, 16, v10
    v_and_b32 v53, 0xffff0000, v10
    v_add_f32 v47, v47, v52
    v_add_f32 v50, v50, v53
    v_lshlrev_b32_e64 v54, 16, v11
    v_and_b32 v55, 0xffff0000, v11
    v_add_f32 v47, v47, v54
    v_add_f32 v50, v50, v55
    v_lshlrev_b32_e64 v52, 16, v12
    v_and_b32 v53, 0xffff0000, v12
    v_add_f32 v48, v48, v52
    v_add_f32 v51, v51, v53
    v_lshlrev_b32_e64 v54, 16, v13
    v_and_b32 v55, 0xffff0000, v13
    v_add_f32 v48, v48, v54
    v_add_f32 v51, v51, v55
    v_lshlrev_b32_e64 v52, 16, v14
    v_and_b32 v53, 0xffff0000, v14
    v_add_f32 v48, v48, v52
    v_add_f32 v51, v51, v53
    v_lshlrev_b32_e64 v54, 16, v15
    v_and_b32 v55, 0xffff0000, v15
    v_add_f32 v48, v48, v54
    v_add_f32 v51, v51, v55
    s_waitcnt lgkmcnt(0)
    v_lshlrev_b32 v52, 16, v16
    v_and_b32 v53, 0xffff0000, v16
    v_add_f32 v46, v46, v52
    v_add_f32 v49, v49, v53
    v_lshlrev_b32_e64 v54, 16, v17
    v_and_b32 v55, 0xffff0000, v17
    v_add_f32 v46, v46, v54
    v_add_f32 v49, v49, v55
    v_lshlrev_b32_e64 v52, 16, v18
    v_and_b32 v53, 0xffff0000, v18
    v_add_f32 v46, v46, v52
    v_add_f32 v49, v49, v53
    v_lshlrev_b32_e64 v54, 16, v19
    v_and_b32 v55, 0xffff0000, v19
    v_add_f32 v46, v46, v54
    v_add_f32 v49, v49, v55
    v_lshlrev_b32_e64 v52, 16, v20
    v_and_b32 v53, 0xffff0000, v20
    v_add_f32 v47, v47, v52
    v_add_f32 v50, v50, v53
    v_lshlrev_b32_e64 v54, 16, v21
    v_and_b32 v55, 0xffff0000, v21
    v_add_f32 v47, v47, v54
    v_add_f32 v50, v50, v55
    v_lshlrev_b32_e64 v52, 16, v22
    v_and_b32 v53, 0xffff0000, v22
    v_add_f32 v47, v47, v52
    v_add_f32 v50, v50, v53
    v_lshlrev_b32_e64 v54, 16, v23
    v_and_b32 v55, 0xffff0000, v23
    v_add_f32 v47, v47, v54
    v_add_f32 v50, v50, v55
    v_lshlrev_b32_e64 v52, 16, v24
    v_and_b32 v53, 0xffff0000, v24
    v_add_f32 v48, v48, v52
    v_add_f32 v51, v51, v53
    v_lshlrev_b32_e64 v54, 16, v25
    v_and_b32 v55, 0xffff0000, v25
    v_add_f32 v48, v48, v54
    v_add_f32 v51, v51, v55
    v_lshlrev_b32_e64 v52, 16, v26
    v_and_b32 v53, 0xffff0000, v26
    v_add_f32 v48, v48, v52
    v_add_f32 v51, v51, v53
    v_lshlrev_b32_e64 v54, 16, v27
    v_and_b32 v55, 0xffff0000, v27
    v_add_f32 v48, v48, v54
    v_add_f32 v51, v51, v55
    s_barrier
    ds_read_b64_tr_b16 v[4:5], v44 offset:24576
    ds_read_b64_tr_b16 v[6:7], v44 offset:26112
    ds_read_b64_tr_b16 v[8:9], v45 offset:24608
    ds_read_b64_tr_b16 v[10:11], v45 offset:26144
    ds_read_b64_tr_b16 v[12:13], v44 offset:24640
    ds_read_b64_tr_b16 v[14:15], v44 offset:26176
    ds_read_b64_tr_b16 v[16:17], v44 offset:27648
    ds_read_b64_tr_b16 v[18:19], v44 offset:29184
    ds_read_b64_tr_b16 v[20:21], v45 offset:27680
    ds_read_b64_tr_b16 v[22:23], v45 offset:29216
    ds_read_b64_tr_b16 v[24:25], v44 offset:27712
    ds_read_b64_tr_b16 v[26:27], v44 offset:29248
    s_waitcnt lgkmcnt(6)
    v_lshlrev_b32_e64 v52, 16, v4
    v_and_b32 v53, 0xffff0000, v4
    v_add_f32 v46, v46, v52
    v_add_f32 v49, v49, v53
    v_lshlrev_b32_e64 v54, 16, v5
    v_and_b32 v55, 0xffff0000, v5
    v_add_f32 v46, v46, v54
    v_add_f32 v49, v49, v55
    v_lshlrev_b32_e64 v52, 16, v6
    v_and_b32 v53, 0xffff0000, v6
    v_add_f32 v46, v46, v52
    v_add_f32 v49, v49, v53
    v_lshlrev_b32_e64 v54, 16, v7
    v_and_b32 v55, 0xffff0000, v7
    v_add_f32 v46, v46, v54
    v_add_f32 v49, v49, v55
    v_lshlrev_b32_e64 v52, 16, v8
    v_and_b32 v53, 0xffff0000, v8
    v_add_f32 v47, v47, v52
    v_add_f32 v50, v50, v53
    v_lshlrev_b32_e64 v54, 16, v9
    v_and_b32 v55, 0xffff0000, v9
    v_add_f32 v47, v47, v54
    v_add_f32 v50, v50, v55
    v_lshlrev_b32_e64 v52, 16, v10
    v_and_b32 v53, 0xffff0000, v10
    v_add_f32 v47, v47, v52
    v_add_f32 v50, v50, v53
    v_lshlrev_b32_e64 v54, 16, v11
    v_and_b32 v55, 0xffff0000, v11
    v_add_f32 v47, v47, v54
    v_add_f32 v50, v50, v55
    v_lshlrev_b32_e64 v52, 16, v12
    v_and_b32 v53, 0xffff0000, v12
    v_add_f32 v48, v48, v52
    v_add_f32 v51, v51, v53
    v_lshlrev_b32_e64 v54, 16, v13
    v_and_b32 v55, 0xffff0000, v13
    v_add_f32 v48, v48, v54
    v_add_f32 v51, v51, v55
    v_lshlrev_b32_e64 v52, 16, v14
    v_and_b32 v53, 0xffff0000, v14
    v_add_f32 v48, v48, v52
    v_add_f32 v51, v51, v53
    v_lshlrev_b32_e64 v54, 16, v15
    v_and_b32 v55, 0xffff0000, v15
    v_add_f32 v48, v48, v54
    v_add_f32 v51, v51, v55
    s_waitcnt lgkmcnt(0)
    v_lshlrev_b32 v52, 16, v16
    v_and_b32 v53, 0xffff0000, v16
    v_add_f32 v46, v46, v52
    v_add_f32 v49, v49, v53
    v_lshlrev_b32_e64 v54, 16, v17
    v_and_b32 v55, 0xffff0000, v17
    v_add_f32 v46, v46, v54
    v_add_f32 v49, v49, v55
    v_lshlrev_b32_e64 v52, 16, v18
    v_and_b32 v53, 0xffff0000, v18
    v_add_f32 v46, v46, v52
    v_add_f32 v49, v49, v53
    v_lshlrev_b32_e64 v54, 16, v19
    v_and_b32 v55, 0xffff0000, v19
    v_add_f32 v46, v46, v54
    v_add_f32 v49, v49, v55
    v_lshlrev_b32_e64 v52, 16, v20
    v_and_b32 v53, 0xffff0000, v20
    v_add_f32 v47, v47, v52
    v_add_f32 v50, v50, v53
    v_lshlrev_b32_e64 v54, 16, v21
    v_and_b32 v55, 0xffff0000, v21
    v_add_f32 v47, v47, v54
    v_add_f32 v50, v50, v55
    v_lshlrev_b32_e64 v52, 16, v22
    v_and_b32 v53, 0xffff0000, v22
    v_add_f32 v47, v47, v52
    v_add_f32 v50, v50, v53
    v_lshlrev_b32_e64 v54, 16, v23
    v_and_b32 v55, 0xffff0000, v23
    v_add_f32 v47, v47, v54
    v_add_f32 v50, v50, v55
    v_lshlrev_b32_e64 v52, 16, v24
    v_and_b32 v53, 0xffff0000, v24
    v_add_f32 v48, v48, v52
    v_add_f32 v51, v51, v53
    v_lshlrev_b32_e64 v54, 16, v25
    v_and_b32 v55, 0xffff0000, v25
    v_add_f32 v48, v48, v54
    v_add_f32 v51, v51, v55
    v_lshlrev_b32_e64 v52, 16, v26
    v_and_b32 v53, 0xffff0000, v26
    v_add_f32 v48, v48, v52
    v_add_f32 v51, v51, v53
    v_lshlrev_b32_e64 v54, 16, v27
    v_and_b32 v55, 0xffff0000, v27
    v_add_f32 v48, v48, v54
    v_add_f32 v51, v51, v55
    s_barrier
    ds_read_b64_tr_b16 v[4:5], v44 offset:49152
    ds_read_b64_tr_b16 v[6:7], v44 offset:50688
    ds_read_b64_tr_b16 v[8:9], v45 offset:49184
    ds_read_b64_tr_b16 v[10:11], v45 offset:50720
    ds_read_b64_tr_b16 v[12:13], v44 offset:49216
    ds_read_b64_tr_b16 v[14:15], v44 offset:50752
    ds_read_b64_tr_b16 v[16:17], v44 offset:52224
    ds_read_b64_tr_b16 v[18:19], v44 offset:53760
    ds_read_b64_tr_b16 v[20:21], v45 offset:52256
    ds_read_b64_tr_b16 v[22:23], v45 offset:53792
    ds_read_b64_tr_b16 v[24:25], v44 offset:52288
    ds_read_b64_tr_b16 v[26:27], v44 offset:53824
    s_waitcnt lgkmcnt(6)
    v_lshlrev_b32_e64 v52, 16, v4
    v_and_b32 v53, 0xffff0000, v4
    v_add_f32 v46, v46, v52
    v_add_f32 v49, v49, v53
    v_lshlrev_b32_e64 v54, 16, v5
    v_and_b32 v55, 0xffff0000, v5
    v_add_f32 v46, v46, v54
    v_add_f32 v49, v49, v55
    v_lshlrev_b32_e64 v52, 16, v6
    v_and_b32 v53, 0xffff0000, v6
    v_add_f32 v46, v46, v52
    v_add_f32 v49, v49, v53
    v_lshlrev_b32_e64 v54, 16, v7
    v_and_b32 v55, 0xffff0000, v7
    v_add_f32 v46, v46, v54
    v_add_f32 v49, v49, v55
    v_lshlrev_b32_e64 v52, 16, v8
    v_and_b32 v53, 0xffff0000, v8
    v_add_f32 v47, v47, v52
    v_add_f32 v50, v50, v53
    v_lshlrev_b32_e64 v54, 16, v9
    v_and_b32 v55, 0xffff0000, v9
    v_add_f32 v47, v47, v54
    v_add_f32 v50, v50, v55
    v_lshlrev_b32_e64 v52, 16, v10
    v_and_b32 v53, 0xffff0000, v10
    v_add_f32 v47, v47, v52
    v_add_f32 v50, v50, v53
    v_lshlrev_b32_e64 v54, 16, v11
    v_and_b32 v55, 0xffff0000, v11
    v_add_f32 v47, v47, v54
    v_add_f32 v50, v50, v55
    v_lshlrev_b32_e64 v52, 16, v12
    v_and_b32 v53, 0xffff0000, v12
    v_add_f32 v48, v48, v52
    v_add_f32 v51, v51, v53
    v_lshlrev_b32_e64 v54, 16, v13
    v_and_b32 v55, 0xffff0000, v13
    v_add_f32 v48, v48, v54
    v_add_f32 v51, v51, v55
    v_lshlrev_b32_e64 v52, 16, v14
    v_and_b32 v53, 0xffff0000, v14
    v_add_f32 v48, v48, v52
    v_add_f32 v51, v51, v53
    v_lshlrev_b32_e64 v54, 16, v15
    v_and_b32 v55, 0xffff0000, v15
    v_add_f32 v48, v48, v54
    v_add_f32 v51, v51, v55
    s_waitcnt lgkmcnt(0)
    v_lshlrev_b32 v52, 16, v16
    v_and_b32 v53, 0xffff0000, v16
    v_add_f32 v46, v46, v52
    v_add_f32 v49, v49, v53
    v_lshlrev_b32_e64 v54, 16, v17
    v_and_b32 v55, 0xffff0000, v17
    v_add_f32 v46, v46, v54
    v_add_f32 v49, v49, v55
    v_lshlrev_b32_e64 v52, 16, v18
    v_and_b32 v53, 0xffff0000, v18
    v_add_f32 v46, v46, v52
    v_add_f32 v49, v49, v53
    v_lshlrev_b32_e64 v54, 16, v19
    v_and_b32 v55, 0xffff0000, v19
    v_add_f32 v46, v46, v54
    v_add_f32 v49, v49, v55
    v_lshlrev_b32_e64 v52, 16, v20
    v_and_b32 v53, 0xffff0000, v20
    v_add_f32 v47, v47, v52
    v_add_f32 v50, v50, v53
    v_lshlrev_b32_e64 v54, 16, v21
    v_and_b32 v55, 0xffff0000, v21
    v_add_f32 v47, v47, v54
    v_add_f32 v50, v50, v55
    v_lshlrev_b32_e64 v52, 16, v22
    v_and_b32 v53, 0xffff0000, v22
    v_add_f32 v47, v47, v52
    v_add_f32 v50, v50, v53
    v_lshlrev_b32_e64 v54, 16, v23
    v_and_b32 v55, 0xffff0000, v23
    v_add_f32 v47, v47, v54
    v_add_f32 v50, v50, v55
    v_lshlrev_b32_e64 v52, 16, v24
    v_and_b32 v53, 0xffff0000, v24
    v_add_f32 v48, v48, v52
    v_add_f32 v51, v51, v53
    v_lshlrev_b32_e64 v54, 16, v25
    v_and_b32 v55, 0xffff0000, v25
    v_add_f32 v48, v48, v54
    v_add_f32 v51, v51, v55
    v_lshlrev_b32_e64 v52, 16, v26
    v_and_b32 v53, 0xffff0000, v26
    v_add_f32 v48, v48, v52
    v_add_f32 v51, v51, v53
    v_lshlrev_b32_e64 v54, 16, v27
    v_and_b32 v55, 0xffff0000, v27
    v_add_f32 v48, v48, v54
    v_add_f32 v51, v51, v55
    s_barrier
    ds_read_b64_tr_b16 v[4:5], v44 offset:0
    ds_read_b64_tr_b16 v[6:7], v44 offset:1536
    ds_read_b64_tr_b16 v[8:9], v45 offset:32
    ds_read_b64_tr_b16 v[10:11], v45 offset:1568
    ds_read_b64_tr_b16 v[12:13], v44 offset:64
    ds_read_b64_tr_b16 v[14:15], v44 offset:1600
    ds_read_b64_tr_b16 v[16:17], v44 offset:3072
    ds_read_b64_tr_b16 v[18:19], v44 offset:4608
    ds_read_b64_tr_b16 v[20:21], v45 offset:3104
    ds_read_b64_tr_b16 v[22:23], v45 offset:4640
    ds_read_b64_tr_b16 v[24:25], v44 offset:3136
    ds_read_b64_tr_b16 v[26:27], v44 offset:4672
    s_waitcnt lgkmcnt(6)
    v_lshlrev_b32_e64 v52, 16, v4
    v_and_b32 v53, 0xffff0000, v4
    v_add_f32 v46, v46, v52
    v_add_f32 v49, v49, v53
    v_lshlrev_b32_e64 v54, 16, v5
    v_and_b32 v55, 0xffff0000, v5
    v_add_f32 v46, v46, v54
    v_add_f32 v49, v49, v55
    v_lshlrev_b32_e64 v52, 16, v6
    v_and_b32 v53, 0xffff0000, v6
    v_add_f32 v46, v46, v52
    v_add_f32 v49, v49, v53
    v_lshlrev_b32_e64 v54, 16, v7
    v_and_b32 v55, 0xffff0000, v7
    v_add_f32 v46, v46, v54
    v_add_f32 v49, v49, v55
    v_lshlrev_b32_e64 v52, 16, v8
    v_and_b32 v53, 0xffff0000, v8
    v_add_f32 v47, v47, v52
    v_add_f32 v50, v50, v53
    v_lshlrev_b32_e64 v54, 16, v9
    v_and_b32 v55, 0xffff0000, v9
    v_add_f32 v47, v47, v54
    v_add_f32 v50, v50, v55
    v_lshlrev_b32_e64 v52, 16, v10
    v_and_b32 v53, 0xffff0000, v10
    v_add_f32 v47, v47, v52
    v_add_f32 v50, v50, v53
    v_lshlrev_b32_e64 v54, 16, v11
    v_and_b32 v55, 0xffff0000, v11
    v_add_f32 v47, v47, v54
    v_add_f32 v50, v50, v55
    v_lshlrev_b32_e64 v52, 16, v12
    v_and_b32 v53, 0xffff0000, v12
    v_add_f32 v48, v48, v52
    v_add_f32 v51, v51, v53
    v_lshlrev_b32_e64 v54, 16, v13
    v_and_b32 v55, 0xffff0000, v13
    v_add_f32 v48, v48, v54
    v_add_f32 v51, v51, v55
    v_lshlrev_b32_e64 v52, 16, v14
    v_and_b32 v53, 0xffff0000, v14
    v_add_f32 v48, v48, v52
    v_add_f32 v51, v51, v53
    v_lshlrev_b32_e64 v54, 16, v15
    v_and_b32 v55, 0xffff0000, v15
    v_add_f32 v48, v48, v54
    v_add_f32 v51, v51, v55
    s_waitcnt lgkmcnt(0)
    v_lshlrev_b32 v52, 16, v16
    v_and_b32 v53, 0xffff0000, v16
    v_add_f32 v46, v46, v52
    v_add_f32 v49, v49, v53
    v_lshlrev_b32_e64 v54, 16, v17
    v_and_b32 v55, 0xffff0000, v17
    v_add_f32 v46, v46, v54
    v_add_f32 v49, v49, v55
    v_lshlrev_b32_e64 v52, 16, v18
    v_and_b32 v53, 0xffff0000, v18
    v_add_f32 v46, v46, v52
    v_add_f32 v49, v49, v53
    v_lshlrev_b32_e64 v54, 16, v19
    v_and_b32 v55, 0xffff0000, v19
    v_add_f32 v46, v46, v54
    v_add_f32 v49, v49, v55
    v_lshlrev_b32_e64 v52, 16, v20
    v_and_b32 v53, 0xffff0000, v20
    v_add_f32 v47, v47, v52
    v_add_f32 v50, v50, v53
    v_lshlrev_b32_e64 v54, 16, v21
    v_and_b32 v55, 0xffff0000, v21
    v_add_f32 v47, v47, v54
    v_add_f32 v50, v50, v55
    v_lshlrev_b32_e64 v52, 16, v22
    v_and_b32 v53, 0xffff0000, v22
    v_add_f32 v47, v47, v52
    v_add_f32 v50, v50, v53
    v_lshlrev_b32_e64 v54, 16, v23
    v_and_b32 v55, 0xffff0000, v23
    v_add_f32 v47, v47, v54
    v_add_f32 v50, v50, v55
    v_lshlrev_b32_e64 v52, 16, v24
    v_and_b32 v53, 0xffff0000, v24
    v_add_f32 v48, v48, v52
    v_add_f32 v51, v51, v53
    v_lshlrev_b32_e64 v54, 16, v25
    v_and_b32 v55, 0xffff0000, v25
    v_add_f32 v48, v48, v54
    v_add_f32 v51, v51, v55
    v_lshlrev_b32_e64 v52, 16, v26
    v_and_b32 v53, 0xffff0000, v26
    v_add_f32 v48, v48, v52
    v_add_f32 v51, v51, v53
    v_lshlrev_b32_e64 v54, 16, v27
    v_and_b32 v55, 0xffff0000, v27
    v_add_f32 v48, v48, v54
    v_add_f32 v51, v51, v55
    s_barrier
    ds_read_b64_tr_b16 v[4:5], v44 offset:24576
    ds_read_b64_tr_b16 v[6:7], v44 offset:26112
    ds_read_b64_tr_b16 v[8:9], v45 offset:24608
    ds_read_b64_tr_b16 v[10:11], v45 offset:26144
    ds_read_b64_tr_b16 v[12:13], v44 offset:24640
    ds_read_b64_tr_b16 v[14:15], v44 offset:26176
    ds_read_b64_tr_b16 v[16:17], v44 offset:27648
    ds_read_b64_tr_b16 v[18:19], v44 offset:29184
    ds_read_b64_tr_b16 v[20:21], v45 offset:27680
    ds_read_b64_tr_b16 v[22:23], v45 offset:29216
    ds_read_b64_tr_b16 v[24:25], v44 offset:27712
    ds_read_b64_tr_b16 v[26:27], v44 offset:29248
    s_waitcnt lgkmcnt(6)
    v_lshlrev_b32_e64 v52, 16, v4
    v_and_b32 v53, 0xffff0000, v4
    v_add_f32 v46, v46, v52
    v_add_f32 v49, v49, v53
    v_lshlrev_b32_e64 v54, 16, v5
    v_and_b32 v55, 0xffff0000, v5
    v_add_f32 v46, v46, v54
    v_add_f32 v49, v49, v55
    v_lshlrev_b32_e64 v52, 16, v6
    v_and_b32 v53, 0xffff0000, v6
    v_add_f32 v46, v46, v52
    v_add_f32 v49, v49, v53
    v_lshlrev_b32_e64 v54, 16, v7
    v_and_b32 v55, 0xffff0000, v7
    v_add_f32 v46, v46, v54
    v_add_f32 v49, v49, v55
    v_lshlrev_b32_e64 v52, 16, v8
    v_and_b32 v53, 0xffff0000, v8
    v_add_f32 v47, v47, v52
    v_add_f32 v50, v50, v53
    v_lshlrev_b32_e64 v54, 16, v9
    v_and_b32 v55, 0xffff0000, v9
    v_add_f32 v47, v47, v54
    v_add_f32 v50, v50, v55
    v_lshlrev_b32_e64 v52, 16, v10
    v_and_b32 v53, 0xffff0000, v10
    v_add_f32 v47, v47, v52
    v_add_f32 v50, v50, v53
    v_lshlrev_b32_e64 v54, 16, v11
    v_and_b32 v55, 0xffff0000, v11
    v_add_f32 v47, v47, v54
    v_add_f32 v50, v50, v55
    v_lshlrev_b32_e64 v52, 16, v12
    v_and_b32 v53, 0xffff0000, v12
    v_add_f32 v48, v48, v52
    v_add_f32 v51, v51, v53
    v_lshlrev_b32_e64 v54, 16, v13
    v_and_b32 v55, 0xffff0000, v13
    v_add_f32 v48, v48, v54
    v_add_f32 v51, v51, v55
    v_lshlrev_b32_e64 v52, 16, v14
    v_and_b32 v53, 0xffff0000, v14
    v_add_f32 v48, v48, v52
    v_add_f32 v51, v51, v53
    v_lshlrev_b32_e64 v54, 16, v15
    v_and_b32 v55, 0xffff0000, v15
    v_add_f32 v48, v48, v54
    v_add_f32 v51, v51, v55
    s_waitcnt lgkmcnt(0)
    v_lshlrev_b32 v52, 16, v16
    v_and_b32 v53, 0xffff0000, v16
    v_add_f32 v46, v46, v52
    v_add_f32 v49, v49, v53
    v_lshlrev_b32_e64 v54, 16, v17
    v_and_b32 v55, 0xffff0000, v17
    v_add_f32 v46, v46, v54
    v_add_f32 v49, v49, v55
    v_lshlrev_b32_e64 v52, 16, v18
    v_and_b32 v53, 0xffff0000, v18
    v_add_f32 v46, v46, v52
    v_add_f32 v49, v49, v53
    v_lshlrev_b32_e64 v54, 16, v19
    v_and_b32 v55, 0xffff0000, v19
    v_add_f32 v46, v46, v54
    v_add_f32 v49, v49, v55
    v_lshlrev_b32_e64 v52, 16, v20
    v_and_b32 v53, 0xffff0000, v20
    v_add_f32 v47, v47, v52
    v_add_f32 v50, v50, v53
    v_lshlrev_b32_e64 v54, 16, v21
    v_and_b32 v55, 0xffff0000, v21
    v_add_f32 v47, v47, v54
    v_add_f32 v50, v50, v55
    v_lshlrev_b32_e64 v52, 16, v22
    v_and_b32 v53, 0xffff0000, v22
    v_add_f32 v47, v47, v52
    v_add_f32 v50, v50, v53
    v_lshlrev_b32_e64 v54, 16, v23
    v_and_b32 v55, 0xffff0000, v23
    v_add_f32 v47, v47, v54
    v_add_f32 v50, v50, v55
    v_lshlrev_b32_e64 v52, 16, v24
    v_and_b32 v53, 0xffff0000, v24
    v_add_f32 v48, v48, v52
    v_add_f32 v51, v51, v53
    v_lshlrev_b32_e64 v54, 16, v25
    v_and_b32 v55, 0xffff0000, v25
    v_add_f32 v48, v48, v54
    v_add_f32 v51, v51, v55
    v_lshlrev_b32_e64 v52, 16, v26
    v_and_b32 v53, 0xffff0000, v26
    v_add_f32 v48, v48, v52
    v_add_f32 v51, v51, v53
    v_lshlrev_b32_e64 v54, 16, v27
    v_and_b32 v55, 0xffff0000, v27
    v_add_f32 v48, v48, v54
    v_add_f32 v51, v51, v55
    s_barrier
    ds_read_b64_tr_b16 v[4:5], v44 offset:49152
    ds_read_b64_tr_b16 v[6:7], v44 offset:50688
    ds_read_b64_tr_b16 v[8:9], v45 offset:49184
    ds_read_b64_tr_b16 v[10:11], v45 offset:50720
    ds_read_b64_tr_b16 v[12:13], v44 offset:49216
    ds_read_b64_tr_b16 v[14:15], v44 offset:50752
    ds_read_b64_tr_b16 v[16:17], v44 offset:52224
    ds_read_b64_tr_b16 v[18:19], v44 offset:53760
    ds_read_b64_tr_b16 v[20:21], v45 offset:52256
    ds_read_b64_tr_b16 v[22:23], v45 offset:53792
    ds_read_b64_tr_b16 v[24:25], v44 offset:52288
    ds_read_b64_tr_b16 v[26:27], v44 offset:53824
    s_waitcnt lgkmcnt(6)
    v_lshlrev_b32_e64 v52, 16, v4
    v_and_b32 v53, 0xffff0000, v4
    v_add_f32 v46, v46, v52
    v_add_f32 v49, v49, v53
    v_lshlrev_b32_e64 v54, 16, v5
    v_and_b32 v55, 0xffff0000, v5
    v_add_f32 v46, v46, v54
    v_add_f32 v49, v49, v55
    v_lshlrev_b32_e64 v52, 16, v6
    v_and_b32 v53, 0xffff0000, v6
    v_add_f32 v46, v46, v52
    v_add_f32 v49, v49, v53
    v_lshlrev_b32_e64 v54, 16, v7
    v_and_b32 v55, 0xffff0000, v7
    v_add_f32 v46, v46, v54
    v_add_f32 v49, v49, v55
    v_lshlrev_b32_e64 v52, 16, v8
    v_and_b32 v53, 0xffff0000, v8
    v_add_f32 v47, v47, v52
    v_add_f32 v50, v50, v53
    v_lshlrev_b32_e64 v54, 16, v9
    v_and_b32 v55, 0xffff0000, v9
    v_add_f32 v47, v47, v54
    v_add_f32 v50, v50, v55
    v_lshlrev_b32_e64 v52, 16, v10
    v_and_b32 v53, 0xffff0000, v10
    v_add_f32 v47, v47, v52
    v_add_f32 v50, v50, v53
    v_lshlrev_b32_e64 v54, 16, v11
    v_and_b32 v55, 0xffff0000, v11
    v_add_f32 v47, v47, v54
    v_add_f32 v50, v50, v55
    v_lshlrev_b32_e64 v52, 16, v12
    v_and_b32 v53, 0xffff0000, v12
    v_add_f32 v48, v48, v52
    v_add_f32 v51, v51, v53
    v_lshlrev_b32_e64 v54, 16, v13
    v_and_b32 v55, 0xffff0000, v13
    v_add_f32 v48, v48, v54
    v_add_f32 v51, v51, v55
    v_lshlrev_b32_e64 v52, 16, v14
    v_and_b32 v53, 0xffff0000, v14
    v_add_f32 v48, v48, v52
    v_add_f32 v51, v51, v53
    v_lshlrev_b32_e64 v54, 16, v15
    v_and_b32 v55, 0xffff0000, v15
    v_add_f32 v48, v48, v54
    v_add_f32 v51, v51, v55
    s_waitcnt lgkmcnt(0)
    v_lshlrev_b32 v52, 16, v16
    v_and_b32 v53, 0xffff0000, v16
    v_add_f32 v46, v46, v52
    v_add_f32 v49, v49, v53
    v_lshlrev_b32_e64 v54, 16, v17
    v_and_b32 v55, 0xffff0000, v17
    v_add_f32 v46, v46, v54
    v_add_f32 v49, v49, v55
    v_lshlrev_b32_e64 v52, 16, v18
    v_and_b32 v53, 0xffff0000, v18
    v_add_f32 v46, v46, v52
    v_add_f32 v49, v49, v53
    v_lshlrev_b32_e64 v54, 16, v19
    v_and_b32 v55, 0xffff0000, v19
    v_add_f32 v46, v46, v54
    v_add_f32 v49, v49, v55
    v_lshlrev_b32_e64 v52, 16, v20
    v_and_b32 v53, 0xffff0000, v20
    v_add_f32 v47, v47, v52
    v_add_f32 v50, v50, v53
    v_lshlrev_b32_e64 v54, 16, v21
    v_and_b32 v55, 0xffff0000, v21
    v_add_f32 v47, v47, v54
    v_add_f32 v50, v50, v55
    v_lshlrev_b32_e64 v52, 16, v22
    v_and_b32 v53, 0xffff0000, v22
    v_add_f32 v47, v47, v52
    v_add_f32 v50, v50, v53
    v_lshlrev_b32_e64 v54, 16, v23
    v_and_b32 v55, 0xffff0000, v23
    v_add_f32 v47, v47, v54
    v_add_f32 v50, v50, v55
    v_lshlrev_b32_e64 v52, 16, v24
    v_and_b32 v53, 0xffff0000, v24
    v_add_f32 v48, v48, v52
    v_add_f32 v51, v51, v53
    v_lshlrev_b32_e64 v54, 16, v25
    v_and_b32 v55, 0xffff0000, v25
    v_add_f32 v48, v48, v54
    v_add_f32 v51, v51, v55
    v_lshlrev_b32_e64 v52, 16, v26
    v_and_b32 v53, 0xffff0000, v26
    v_add_f32 v48, v48, v52
    v_add_f32 v51, v51, v53
    v_lshlrev_b32_e64 v54, 16, v27
    v_and_b32 v55, 0xffff0000, v27
    v_add_f32 v48, v48, v54
    v_add_f32 v51, v51, v55
    s_barrier
    ds_read_b64_tr_b16 v[4:5], v44 offset:0
    ds_read_b64_tr_b16 v[6:7], v44 offset:1536
    ds_read_b64_tr_b16 v[8:9], v45 offset:32
    ds_read_b64_tr_b16 v[10:11], v45 offset:1568
    ds_read_b64_tr_b16 v[12:13], v44 offset:64
    ds_read_b64_tr_b16 v[14:15], v44 offset:1600
    ds_read_b64_tr_b16 v[16:17], v44 offset:3072
    ds_read_b64_tr_b16 v[18:19], v44 offset:4608
    ds_read_b64_tr_b16 v[20:21], v45 offset:3104
    ds_read_b64_tr_b16 v[22:23], v45 offset:4640
    ds_read_b64_tr_b16 v[24:25], v44 offset:3136
    ds_read_b64_tr_b16 v[26:27], v44 offset:4672
    buffer_load_dwordx2 v[28:29], v62, s[28:31], s50 offen offset:0 sc1
    buffer_load_dwordx2 v[30:31], v62, s[28:31], s50 offen offset:512 sc1
    buffer_load_dwordx2 v[32:33], v62, s[28:31], s50 offen offset:1024 sc1
    buffer_load_dwordx2 v[34:35], v62, s[28:31], s50 offen offset:1536 sc1
    buffer_load_dwordx2 v[36:37], v62, s[28:31], s50 offen offset:2048 sc1
    buffer_load_dwordx2 v[38:39], v62, s[28:31], s50 offen offset:2560 sc1
    buffer_load_dwordx2 v[40:41], v62, s[28:31], s50 offen offset:3072 sc1
    buffer_load_dwordx2 v[42:43], v62, s[28:31], s50 offen offset:3584 sc1
    s_waitcnt lgkmcnt(6)
    v_lshlrev_b32_e64 v52, 16, v4
    v_and_b32 v53, 0xffff0000, v4
    v_add_f32 v46, v46, v52
    v_add_f32 v49, v49, v53
    v_lshlrev_b32_e64 v54, 16, v5
    v_and_b32 v55, 0xffff0000, v5
    v_add_f32 v46, v46, v54
    v_add_f32 v49, v49, v55
    v_lshlrev_b32_e64 v52, 16, v6
    v_and_b32 v53, 0xffff0000, v6
    v_add_f32 v46, v46, v52
    v_add_f32 v49, v49, v53
    v_lshlrev_b32_e64 v54, 16, v7
    v_and_b32 v55, 0xffff0000, v7
    v_add_f32 v46, v46, v54
    v_add_f32 v49, v49, v55
    v_lshlrev_b32_e64 v52, 16, v8
    v_and_b32 v53, 0xffff0000, v8
    v_add_f32 v47, v47, v52
    v_add_f32 v50, v50, v53
    v_lshlrev_b32_e64 v54, 16, v9
    v_and_b32 v55, 0xffff0000, v9
    v_add_f32 v47, v47, v54
    v_add_f32 v50, v50, v55
    v_lshlrev_b32_e64 v52, 16, v10
    v_and_b32 v53, 0xffff0000, v10
    v_add_f32 v47, v47, v52
    v_add_f32 v50, v50, v53
    v_lshlrev_b32_e64 v54, 16, v11
    v_and_b32 v55, 0xffff0000, v11
    v_add_f32 v47, v47, v54
    v_add_f32 v50, v50, v55
    v_lshlrev_b32_e64 v52, 16, v12
    v_and_b32 v53, 0xffff0000, v12
    v_add_f32 v48, v48, v52
    v_add_f32 v51, v51, v53
    v_lshlrev_b32_e64 v54, 16, v13
    v_and_b32 v55, 0xffff0000, v13
    v_add_f32 v48, v48, v54
    v_add_f32 v51, v51, v55
    v_lshlrev_b32_e64 v52, 16, v14
    v_and_b32 v53, 0xffff0000, v14
    v_add_f32 v48, v48, v52
    v_add_f32 v51, v51, v53
    v_lshlrev_b32_e64 v54, 16, v15
    v_and_b32 v55, 0xffff0000, v15
    v_add_f32 v48, v48, v54
    v_add_f32 v51, v51, v55
    s_waitcnt lgkmcnt(0)
    v_lshlrev_b32 v52, 16, v16
    v_and_b32 v53, 0xffff0000, v16
    v_add_f32 v46, v46, v52
    v_add_f32 v49, v49, v53
    v_lshlrev_b32_e64 v54, 16, v17
    v_and_b32 v55, 0xffff0000, v17
    v_add_f32 v46, v46, v54
    v_add_f32 v49, v49, v55
    v_lshlrev_b32_e64 v52, 16, v18
    v_and_b32 v53, 0xffff0000, v18
    v_add_f32 v46, v46, v52
    v_add_f32 v49, v49, v53
    v_lshlrev_b32_e64 v54, 16, v19
    v_and_b32 v55, 0xffff0000, v19
    v_add_f32 v46, v46, v54
    v_add_f32 v49, v49, v55
    v_lshlrev_b32_e64 v52, 16, v20
    v_and_b32 v53, 0xffff0000, v20
    v_add_f32 v47, v47, v52
    v_add_f32 v50, v50, v53
    v_lshlrev_b32_e64 v54, 16, v21
    v_and_b32 v55, 0xffff0000, v21
    v_add_f32 v47, v47, v54
    v_add_f32 v50, v50, v55
    v_lshlrev_b32_e64 v52, 16, v22
    v_and_b32 v53, 0xffff0000, v22
    v_add_f32 v47, v47, v52
    v_add_f32 v50, v50, v53
    v_lshlrev_b32_e64 v54, 16, v23
    v_and_b32 v55, 0xffff0000, v23
    v_add_f32 v47, v47, v54
    v_add_f32 v50, v50, v55
    v_lshlrev_b32_e64 v52, 16, v24
    v_and_b32 v53, 0xffff0000, v24
    v_add_f32 v48, v48, v52
    v_add_f32 v51, v51, v53
    v_lshlrev_b32_e64 v54, 16, v25
    v_and_b32 v55, 0xffff0000, v25
    v_add_f32 v48, v48, v54
    v_add_f32 v51, v51, v55
    v_lshlrev_b32_e64 v52, 16, v26
    v_and_b32 v53, 0xffff0000, v26
    v_add_f32 v48, v48, v52
    v_add_f32 v51, v51, v53
    v_lshlrev_b32_e64 v54, 16, v27
    v_and_b32 v55, 0xffff0000, v27
    v_add_f32 v48, v48, v54
    v_add_f32 v51, v51, v55
    s_barrier
    ds_read_b64_tr_b16 v[4:5], v44 offset:24576
    ds_read_b64_tr_b16 v[6:7], v44 offset:26112
    ds_read_b64_tr_b16 v[8:9], v45 offset:24608
    ds_read_b64_tr_b16 v[10:11], v45 offset:26144
    ds_read_b64_tr_b16 v[12:13], v44 offset:24640
    ds_read_b64_tr_b16 v[14:15], v44 offset:26176
    ds_read_b64_tr_b16 v[16:17], v44 offset:27648
    ds_read_b64_tr_b16 v[18:19], v44 offset:29184
    ds_read_b64_tr_b16 v[20:21], v45 offset:27680
    ds_read_b64_tr_b16 v[22:23], v45 offset:29216
    ds_read_b64_tr_b16 v[24:25], v44 offset:27712
    ds_read_b64_tr_b16 v[26:27], v44 offset:29248
    s_waitcnt lgkmcnt(6)
    v_lshlrev_b32_e64 v52, 16, v4
    v_and_b32 v53, 0xffff0000, v4
    v_add_f32 v46, v46, v52
    v_add_f32 v49, v49, v53
    v_lshlrev_b32_e64 v54, 16, v5
    v_and_b32 v55, 0xffff0000, v5
    v_add_f32 v46, v46, v54
    v_add_f32 v49, v49, v55
    v_lshlrev_b32_e64 v52, 16, v6
    v_and_b32 v53, 0xffff0000, v6
    v_add_f32 v46, v46, v52
    v_add_f32 v49, v49, v53
    v_lshlrev_b32_e64 v54, 16, v7
    v_and_b32 v55, 0xffff0000, v7
    v_add_f32 v46, v46, v54
    v_add_f32 v49, v49, v55
    v_lshlrev_b32_e64 v52, 16, v8
    v_and_b32 v53, 0xffff0000, v8
    v_add_f32 v47, v47, v52
    v_add_f32 v50, v50, v53
    v_lshlrev_b32_e64 v54, 16, v9
    v_and_b32 v55, 0xffff0000, v9
    v_add_f32 v47, v47, v54
    v_add_f32 v50, v50, v55
    v_lshlrev_b32_e64 v52, 16, v10
    v_and_b32 v53, 0xffff0000, v10
    v_add_f32 v47, v47, v52
    v_add_f32 v50, v50, v53
    v_lshlrev_b32_e64 v54, 16, v11
    v_and_b32 v55, 0xffff0000, v11
    v_add_f32 v47, v47, v54
    v_add_f32 v50, v50, v55
    v_lshlrev_b32_e64 v52, 16, v12
    v_and_b32 v53, 0xffff0000, v12
    v_add_f32 v48, v48, v52
    v_add_f32 v51, v51, v53
    v_lshlrev_b32_e64 v54, 16, v13
    v_and_b32 v55, 0xffff0000, v13
    v_add_f32 v48, v48, v54
    v_add_f32 v51, v51, v55
    v_lshlrev_b32_e64 v52, 16, v14
    v_and_b32 v53, 0xffff0000, v14
    v_add_f32 v48, v48, v52
    v_add_f32 v51, v51, v53
    v_lshlrev_b32_e64 v54, 16, v15
    v_and_b32 v55, 0xffff0000, v15
    v_add_f32 v48, v48, v54
    v_add_f32 v51, v51, v55
    s_waitcnt lgkmcnt(0)
    v_lshlrev_b32 v52, 16, v16
    v_and_b32 v53, 0xffff0000, v16
    v_add_f32 v46, v46, v52
    v_add_f32 v49, v49, v53
    v_lshlrev_b32_e64 v54, 16, v17
    v_and_b32 v55, 0xffff0000, v17
    v_add_f32 v46, v46, v54
    v_add_f32 v49, v49, v55
    v_lshlrev_b32_e64 v52, 16, v18
    v_and_b32 v53, 0xffff0000, v18
    v_add_f32 v46, v46, v52
    v_add_f32 v49, v49, v53
    v_lshlrev_b32_e64 v54, 16, v19
    v_and_b32 v55, 0xffff0000, v19
    v_add_f32 v46, v46, v54
    v_add_f32 v49, v49, v55
    v_lshlrev_b32_e64 v52, 16, v20
    v_and_b32 v53, 0xffff0000, v20
    v_add_f32 v47, v47, v52
    v_add_f32 v50, v50, v53
    v_lshlrev_b32_e64 v54, 16, v21
    v_and_b32 v55, 0xffff0000, v21
    v_add_f32 v47, v47, v54
    v_add_f32 v50, v50, v55
    v_lshlrev_b32_e64 v52, 16, v22
    v_and_b32 v53, 0xffff0000, v22
    v_add_f32 v47, v47, v52
    v_add_f32 v50, v50, v53
    v_lshlrev_b32_e64 v54, 16, v23
    v_and_b32 v55, 0xffff0000, v23
    v_add_f32 v47, v47, v54
    v_add_f32 v50, v50, v55
    v_lshlrev_b32_e64 v52, 16, v24
    v_and_b32 v53, 0xffff0000, v24
    v_add_f32 v48, v48, v52
    v_add_f32 v51, v51, v53
    v_lshlrev_b32_e64 v54, 16, v25
    v_and_b32 v55, 0xffff0000, v25
    v_add_f32 v48, v48, v54
    v_add_f32 v51, v51, v55
    v_lshlrev_b32_e64 v52, 16, v26
    v_and_b32 v53, 0xffff0000, v26
    v_add_f32 v48, v48, v52
    v_add_f32 v51, v51, v53
    v_lshlrev_b32_e64 v54, 16, v27
    v_and_b32 v55, 0xffff0000, v27
    v_add_f32 v48, v48, v54
    v_add_f32 v51, v51, v55
    v_add_f32 v46, v46, v49
    v_add_f32 v47, v47, v50
    v_add_f32 v48, v48, v51
    v_mov_b32 v61, v46
    s_nop 1
    v_permlane32_swap_b32 v46, v61
    v_add_f32 v46, v46, v61
    v_mov_b32 v61, v47
    s_nop 1
    v_permlane32_swap_b32 v47, v61
    v_add_f32 v47, v47, v61
    v_mov_b32 v61, v48
    s_nop 1
    v_permlane32_swap_b32 v48, v61
    v_add_f32 v48, v48, v61
    s_mul_i32 s40, s46, 384
    s_add_u32 s40, s40, 73728
    v_lshl_add_u32 v59, v56, 2, s40
    ds_write_b32 v59, v46 offset:0
    ds_write_b32 v59, v47 offset:128
    ds_write_b32 v59, v48 offset:256
    s_waitcnt vmcnt(0)
    v_pk_add_f32 v[28:29], v[28:29], v[30:31]
    v_pk_add_f32 v[32:33], v[32:33], v[34:35]
    v_pk_add_f32 v[36:37], v[36:37], v[38:39]
    v_pk_add_f32 v[40:41], v[40:41], v[42:43]
    v_pk_add_f32 v[28:29], v[28:29], v[32:33]
    v_pk_add_f32 v[36:37], v[36:37], v[40:41]
    v_pk_add_f32 v[28:29], v[28:29], v[36:37]
    v_mul_f32 v30, 0xbb000000, v28
    v_mul_f32 v61, 0x3b000000, v29
    v_fma_f32 v61, -v30, v30, v61
    v_max_f32_e64 v61, 0, v61
    v_add_f32 v61, 0x3727c5ac, v61
    v_rsq_f32 v31, v61
    s_lshl_b32 s40, s46, 8
    s_add_u32 s40, s40, 75776
    v_lshl_add_u32 v59, v56, 3, s40
    s_nop 0
    ds_write_b64 v59, v[30:31]
    s_waitcnt lgkmcnt(0)
    s_barrier
C_p4_out:
    s_add_u32 s28, s22, 0x900000
    s_addc_u32 s29, s23, 0
    s_mov_b32 s30, 0x580000
    s_mov_b32 s31, 0x20000
    v_lshlrev_b32 v103, 4, v0
    s_mul_i32 s40, s3, 3072
    s_add_u32 s40, s40, 49152
    v_add_u32 v102, s40, v103
    s_mul_i32 s40, s3, 3
    s_add_u32 s40, s40, 0
    s_lshr_b32 s41, s40, 2
    s_and_b32 s40, s40, 3
    s_cmp_ge_u32 s41, 3
    s_cselect_b32 s42, 1, 0
    s_mul_i32 s43, s42, 3
    s_sub_u32 s41, s41, s43
    s_mul_i32 s43, s59, 3
    s_add_u32 s41, s41, s43
    s_lshl_b32 s43, s58, 1
    s_add_u32 s42, s42, s43
    s_mul_i32 s42, s42, 180224
    s_min_u32 s41, s41, 43
    s_lshl_b32 s41, s41, 12
    s_add_u32 s42, s42, s41
    s_lshl_b32 s40, s40, 10
    s_add_u32 s48, s42, s40
    s_mul_i32 s40, s3, 3
    s_add_u32 s40, s40, 1
    s_lshr_b32 s41, s40, 2
    s_and_b32 s40, s40, 3
    s_cmp_ge_u32 s41, 3
    s_cselect_b32 s42, 1, 0
    s_mul_i32 s43, s42, 3
    s_sub_u32 s41, s41, s43
    s_mul_i32 s43, s59, 3
    s_add_u32 s41, s41, s43
    s_lshl_b32 s43, s58, 1
    s_add_u32 s42, s42, s43
    s_mul_i32 s42, s42, 180224
    s_min_u32 s41, s41, 43
    s_lshl_b32 s41, s41, 12
    s_add_u32 s42, s42, s41
    s_lshl_b32 s40, s40, 10
    s_add_u32 s49, s42, s40
    s_mul_i32 s40, s3, 3
    s_add_u32 s40, s40, 2
    s_lshr_b32 s41, s40, 2
    s_and_b32 s40, s40, 3
    s_cmp_ge_u32 s41, 3
    s_cselect_b32 s42, 1, 0
    s_mul_i32 s43, s42, 3
    s_sub_u32 s41, s41, s43
    s_mul_i32 s43, s59, 3
    s_add_u32 s41, s41, s43
    s_lshl_b32 s43, s58, 1
    s_add_u32 s42, s42, s43
    s_mul_i32 s42, s42, 180224
    s_min_u32 s41, s41, 43
    s_lshl_b32 s41, s41, 12
    s_add_u32 s42, s42, s41
    s_lshl_b32 s40, s40, 10
    s_add_u32 s50, s42, s40
    s_waitcnt lgkmcnt(0)
    s_barrier
    ds_read_b128 v[104:107], v102 offset:0
    ds_read_b128 v[108:111], v102 offset:1024
    ds_read_b128 v[112:115], v102 offset:2048
    s_waitcnt lgkmcnt(0)
    s_cmp_eq_u32 s27, 0
    s_cbranch_scc1 tw_13
    buffer_store_dwordx4 v[104:107], v103, s[28:31], s48 offen
    buffer_store_dwordx4 v[108:111], v103, s[28:31], s49 offen
    buffer_store_dwordx4 v[112:115], v103, s[28:31], s50 offen
tw_13_e:
    s_waitcnt vmcnt(0)
    s_barrier
C_p5:
    s_and_b32 s46, s3, 1
    s_bfe_u32 s47, s3, 0x10001
    s_lshr_b32 s48, s3, 2
    v_and_b32 v89, 31, v0
    v_lshrrev_b32_e64 v90, 5, v0
    s_lshl_b32 s49, s48, 13
    v_bfe_u32 v91, v0, 2, 2
    v_xor_b32 v91, v91, v90
    v_lshlrev_b32 v91, 4, v91
    v_lshl_add_u32 v91, v89, 6, v91
    s_lshl_b32 s40, s46, 11
    s_add_u32 s40, s40, s49
    v_add_u32 v84, s40, v91
    v_xor_b32 v85, 32, v84
    v_bfe_u32 v91, v0, 2, 2
    v_lshl_add_u32 v92, v90, 2, v91
    v_bfe_u32 v93, v0, 4, 1
    v_bfe_u32 v94, v0, 1, 1
    v_lshl_add_u32 v93, v93, 1, v94
    s_lshl_b32 s40, s47, 2
    v_add_u32 v93, s40, v93
    v_bfe_u32 v94, v0, 3, 1
    v_lshlrev_b32 v94, 2, v94
    v_xor_b32 v93, v93, v94
    v_lshlrev_b32_e64 v93, 4, v93
    v_lshl_add_u32 v93, v92, 7, v93
    v_and_b32_e64 v94, 1, v0
    v_lshl_add_u32 v88, v94, 3, v93
    v_add_u32 v88, 98304, v88
    v_add_u32 v88, s49, v88
    v_lshlrev_b32 v115, 4, v0
    s_xor_b32 s40, s3, 4
    s_lshl_b32 s40, s40, 11
    s_add_u32 s40, s40, 65536
    v_add_u32 v112, s40, v115
    s_lshl_b32 s40, s3, 11
    s_add_u32 s40, s40, 65536
    v_add_u32 v113, s40, v115
    s_lshl_b32 s51, s47, 1
    s_add_u32 s51, s51, s48
    v_lshlrev_b32 v114, 10, v89
    v_lshl_add_u32 v114, v90, 4, v114
    s_mov_b32 s28, s18
    s_mov_b32 s29, s19
    s_mov_b32 s30, 0x200000
    s_mov_b32 s31, 0x20000
    s_lshl_b32 s42, s56, 16
    s_lshl_b32 s40, s46, 15
    s_add_u32 s42, s42, s40
    s_lshl_b32 s40, s57, 7
    s_add_u32 s42, s42, s40
    s_lshl_b32 s40, s51, 5
    s_add_u32 s42, s42, s40
    s_lshl_b32 s40, s3, 10
    s_add_u32 s41, s40, 81920
    v_add_u32 v116, s41, v115
    s_barrier
    ds_read_b128 v[20:23], v84 offset:0
    ds_read_b64_tr_b16 v[24:25], v88 offset:0
    ds_read_b64_tr_b16 v[26:27], v88 offset:1024
    ds_read_b128 v[28:31], v85 offset:0
    ds_read_b64_tr_b16 v[32:33], v88 offset:2048
    ds_read_b64_tr_b16 v[34:35], v88 offset:3072
    ds_read_b128 v[36:39], v84 offset:4096
    ds_read_b64_tr_b16 v[40:41], v88 offset:4096
    ds_read_b64_tr_b16 v[42:43], v88 offset:5120
    ds_read_b128 v[44:47], v85 offset:4096
    ds_read_b64_tr_b16 v[48:49], v88 offset:6144
    ds_read_b64_tr_b16 v[50:51], v88 offset:7168
    s_waitcnt lgkmcnt(0)
    s_barrier
    ds_read_b128 v[52:55], v84 offset:16384
    ds_read_b64_tr_b16 v[56:57], v88 offset:16384
    ds_read_b64_tr_b16 v[58:59], v88 offset:17408
    ds_read_b128 v[60:63], v85 offset:16384
    ds_read_b64_tr_b16 v[64:65], v88 offset:18432
    ds_read_b64_tr_b16 v[66:67], v88 offset:19456
    ds_read_b128 v[68:71], v84 offset:20480
    ds_read_b64_tr_b16 v[72:73], v88 offset:20480
    ds_read_b64_tr_b16 v[74:75], v88 offset:21504
    ds_read_b128 v[76:79], v85 offset:20480
    ds_read_b64_tr_b16 v[80:81], v88 offset:22528
    ds_read_b64_tr_b16 v[82:83], v88 offset:23552
    v_mfma_f32_32x32x16_bf16 v[4:19], v[24:27], v[20:23], 0
    v_mfma_f32_32x32x16_bf16 v[4:19], v[32:35], v[28:31], v[4:19]
    v_mfma_f32_32x32x16_bf16 v[4:19], v[40:43], v[36:39], v[4:19]
    v_mfma_f32_32x32x16_bf16 v[4:19], v[48:51], v[44:47], v[4:19]
    s_waitcnt lgkmcnt(0)
    s_barrier
    ds_read_b128 v[20:23], v84 offset:32768
    ds_read_b64_tr_b16 v[24:25], v88 offset:32768
    ds_read_b64_tr_b16 v[26:27], v88 offset:33792
    ds_read_b128 v[28:31], v85 offset:32768
    ds_read_b64_tr_b16 v[32:33], v88 offset:34816
    ds_read_b64_tr_b16 v[34:35], v88 offset:35840
    ds_read_b128 v[36:39], v84 offset:36864
    ds_read_b64_tr_b16 v[40:41], v88 offset:36864
    ds_read_b64_tr_b16 v[42:43], v88 offset:37888
    ds_read_b128 v[44:47], v85 offset:36864
    ds_read_b64_tr_b16 v[48:49], v88 offset:38912
    ds_read_b64_tr_b16 v[50:51], v88 offset:39936
    v_mfma_f32_32x32x16_bf16 v[4:19], v[56:59], v[52:55], v[4:19]
    v_mfma_f32_32x32x16_bf16 v[4:19], v[64:67], v[60:63], v[4:19]
    v_mfma_f32_32x32x16_bf16 v[4:19], v[72:75], v[68:71], v[4:19]
    v_mfma_f32_32x32x16_bf16 v[4:19], v[80:83], v[76:79], v[4:19]
    s_waitcnt lgkmcnt(0)
    s_barrier
    ds_read_b128 v[52:55], v84 offset:49152
    ds_read_b64_tr_b16 v[56:57], v88 offset:49152
    ds_read_b64_tr_b16 v[58:59], v88 offset:50176
    ds_read_b128 v[60:63], v85 offset:49152
    ds_read_b64_tr_b16 v[64:65], v88 offset:51200
    ds_read_b64_tr_b16 v[66:67], v88 offset:52224
    ds_read_b128 v[68:71], v84 offset:53248
    ds_read_b64_tr_b16 v[72:73], v88 offset:53248
    ds_read_b64_tr_b16 v[74:75], v88 offset:54272
    ds_read_b128 v[76:79], v85 offset:53248
    ds_read_b64_tr_b16 v[80:81], v88 offset:55296
    ds_read_b64_tr_b16 v[82:83], v88 offset:56320
    v_mfma_f32_32x32x16_bf16 v[4:19], v[24:27], v[20:23], v[4:19]
    v_mfma_f32_32x32x16_bf16 v[4:19], v[32:35], v[28:31], v[4:19]
    v_mfma_f32_32x32x16_bf16 v[4:19], v[40:43], v[36:39], v[4:19]
    v_mfma_f32_32x32x16_bf16 v[4:19], v[48:51], v[44:47], v[4:19]
    s_waitcnt lgkmcnt(0)
    s_barrier
    ds_read_b128 v[20:23], v84 offset:0
    ds_read_b64_tr_b16 v[24:25], v88 offset:0
    ds_read_b64_tr_b16 v[26:27], v88 offset:1024
    ds_read_b128 v[28:31], v85 offset:0
    ds_read_b64_tr_b16 v[32:33], v88 offset:2048
    ds_read_b64_tr_b16 v[34:35], v88 offset:3072
    ds_read_b128 v[36:39], v84 offset:4096
    ds_read_b64_tr_b16 v[40:41], v88 offset:4096
    ds_read_b64_tr_b16 v[42:43], v88 offset:5120
    ds_read_b128 v[44:47], v85 offset:4096
    ds_read_b64_tr_b16 v[48:49], v88 offset:6144
    ds_read_b64_tr_b16 v[50:51], v88 offset:7168
    v_mfma_f32_32x32x16_bf16 v[4:19], v[56:59], v[52:55], v[4:19]
    v_mfma_f32_32x32x16_bf16 v[4:19], v[64:67], v[60:63], v[4:19]
    v_mfma_f32_32x32x16_bf16 v[4:19], v[72:75], v[68:71], v[4:19]
    v_mfma_f32_32x32x16_bf16 v[4:19], v[80:83], v[76:79], v[4:19]
    s_waitcnt lgkmcnt(0)
    s_barrier
    ds_read_b128 v[52:55], v84 offset:16384
    ds_read_b64_tr_b16 v[56:57], v88 offset:16384
    ds_read_b64_tr_b16 v[58:59], v88 offset:17408
    ds_read_b128 v[60:63], v85 offset:16384
    ds_read_b64_tr_b16 v[64:65], v88 offset:18432
    ds_read_b64_tr_b16 v[66:67], v88 offset:19456
    ds_read_b128 v[68:71], v84 offset:20480
    ds_read_b64_tr_b16 v[72:73], v88 offset:20480
    ds_read_b64_tr_b16 v[74:75], v88 offset:21504
    ds_read_b128 v[76:79], v85 offset:20480
    ds_read_b64_tr_b16 v[80:81], v88 offset:22528
    ds_read_b64_tr_b16 v[82:83], v88 offset:23552
    v_mfma_f32_32x32x16_bf16 v[4:19], v[24:27], v[20:23], v[4:19]
    v_mfma_f32_32x32x16_bf16 v[4:19], v[32:35], v[28:31], v[4:19]
    v_mfma_f32_32x32x16_bf16 v[4:19], v[40:43], v[36:39], v[4:19]
    v_mfma_f32_32x32x16_bf16 v[4:19], v[48:51], v[44:47], v[4:19]
    s_waitcnt lgkmcnt(0)
    s_barrier
    ds_read_b128 v[20:23], v84 offset:32768
    ds_read_b64_tr_b16 v[24:25], v88 offset:32768
    ds_read_b64_tr_b16 v[26:27], v88 offset:33792
    ds_read_b128 v[28:31], v85 offset:32768
    ds_read_b64_tr_b16 v[32:33], v88 offset:34816
    ds_read_b64_tr_b16 v[34:35], v88 offset:35840
    ds_read_b128 v[36:39], v84 offset:36864
    ds_read_b64_tr_b16 v[40:41], v88 offset:36864
    ds_read_b64_tr_b16 v[42:43], v88 offset:37888
    ds_read_b128 v[44:47], v85 offset:36864
    ds_read_b64_tr_b16 v[48:49], v88 offset:38912
    ds_read_b64_tr_b16 v[50:51], v88 offset:39936
    v_mfma_f32_32x32x16_bf16 v[4:19], v[56:59], v[52:55], v[4:19]
    v_mfma_f32_32x32x16_bf16 v[4:19], v[64:67], v[60:63], v[4:19]
    v_mfma_f32_32x32x16_bf16 v[4:19], v[72:75], v[68:71], v[4:19]
    v_mfma_f32_32x32x16_bf16 v[4:19], v[80:83], v[76:79], v[4:19]
    s_waitcnt lgkmcnt(0)
    s_barrier
    ds_read_b128 v[52:55], v84 offset:49152
    ds_read_b64_tr_b16 v[56:57], v88 offset:49152
    ds_read_b64_tr_b16 v[58:59], v88 offset:50176
    ds_read_b128 v[60:63], v85 offset:49152
    ds_read_b64_tr_b16 v[64:65], v88 offset:51200
    ds_read_b64_tr_b16 v[66:67], v88 offset:52224
    ds_read_b128 v[68:71], v84 offset:53248
    ds_read_b64_tr_b16 v[72:73], v88 offset:53248
    ds_read_b64_tr_b16 v[74:75], v88 offset:54272
    ds_read_b128 v[76:79], v85 offset:53248
    ds_read_b64_tr_b16 v[80:81], v88 offset:55296
    ds_read_b64_tr_b16 v[82:83], v88 offset:56320
    v_mfma_f32_32x32x16_bf16 v[4:19], v[24:27], v[20:23], v[4:19]
    v_mfma_f32_32x32x16_bf16 v[4:19], v[32:35], v[28:31], v[4:19]
    v_mfma_f32_32x32x16_bf16 v[4:19], v[40:43], v[36:39], v[4:19]
    v_mfma_f32_32x32x16_bf16 v[4:19], v[48:51], v[44:47], v[4:19]
    s_waitcnt lgkmcnt(0)
    s_barrier
    ds_read_b128 v[20:23], v84 offset:0
    ds_read_b64_tr_b16 v[24:25], v88 offset:0
    ds_read_b64_tr_b16 v[26:27], v88 offset:1024
    ds_read_b128 v[28:31], v85 offset:0
    ds_read_b64_tr_b16 v[32:33], v88 offset:2048
    ds_read_b64_tr_b16 v[34:35], v88 offset:3072
    ds_read_b128 v[36:39], v84 offset:4096
    ds_read_b64_tr_b16 v[40:41], v88 offset:4096
    ds_read_b64_tr_b16 v[42:43], v88 offset:5120
    ds_read_b128 v[44:47], v85 offset:4096
    ds_read_b64_tr_b16 v[48:49], v88 offset:6144
    ds_read_b64_tr_b16 v[50:51], v88 offset:7168
    v_mfma_f32_32x32x16_bf16 v[4:19], v[56:59], v[52:55], v[4:19]
    v_mfma_f32_32x32x16_bf16 v[4:19], v[64:67], v[60:63], v[4:19]
    v_mfma_f32_32x32x16_bf16 v[4:19], v[72:75], v[68:71], v[4:19]
    v_mfma_f32_32x32x16_bf16 v[4:19], v[80:83], v[76:79], v[4:19]
    s_waitcnt lgkmcnt(0)
    s_barrier
    ds_read_b128 v[52:55], v84 offset:16384
    ds_read_b64_tr_b16 v[56:57], v88 offset:16384
    ds_read_b64_tr_b16 v[58:59], v88 offset:17408
    ds_read_b128 v[60:63], v85 offset:16384
    ds_read_b64_tr_b16 v[64:65], v88 offset:18432
    ds_read_b64_tr_b16 v[66:67], v88 offset:19456
    ds_read_b128 v[68:71], v84 offset:20480
    ds_read_b64_tr_b16 v[72:73], v88 offset:20480
    ds_read_b64_tr_b16 v[74:75], v88 offset:21504
    ds_read_b128 v[76:79], v85 offset:20480
    ds_read_b64_tr_b16 v[80:81], v88 offset:22528
    ds_read_b64_tr_b16 v[82:83], v88 offset:23552
    v_mfma_f32_32x32x16_bf16 v[4:19], v[24:27], v[20:23], v[4:19]
    v_mfma_f32_32x32x16_bf16 v[4:19], v[32:35], v[28:31], v[4:19]
    v_mfma_f32_32x32x16_bf16 v[4:19], v[40:43], v[36:39], v[4:19]
    v_mfma_f32_32x32x16_bf16 v[4:19], v[48:51], v[44:47], v[4:19]
    s_waitcnt lgkmcnt(0)
    s_barrier
    ds_read_b128 v[20:23], v84 offset:32768
    ds_read_b64_tr_b16 v[24:25], v88 offset:32768
    ds_read_b64_tr_b16 v[26:27], v88 offset:33792
    ds_read_b128 v[28:31], v85 offset:32768
    ds_read_b64_tr_b16 v[32:33], v88 offset:34816
    ds_read_b64_tr_b16 v[34:35], v88 offset:35840
    ds_read_b128 v[36:39], v84 offset:36864
    ds_read_b64_tr_b16 v[40:41], v88 offset:36864
    ds_read_b64_tr_b16 v[42:43], v88 offset:37888
    ds_read_b128 v[44:47], v85 offset:36864
    ds_read_b64_tr_b16 v[48:49], v88 offset:38912
    ds_read_b64_tr_b16 v[50:51], v88 offset:39936
    v_mfma_f32_32x32x16_bf16 v[4:19], v[56:59], v[52:55], v[4:19]
    v_mfma_f32_32x32x16_bf16 v[4:19], v[64:67], v[60:63], v[4:19]
    v_mfma_f32_32x32x16_bf16 v[4:19], v[72:75], v[68:71], v[4:19]
    v_mfma_f32_32x32x16_bf16 v[4:19], v[80:83], v[76:79], v[4:19]
    s_waitcnt lgkmcnt(0)
    v_mfma_f32_32x32x16_bf16 v[4:19], v[24:27], v[20:23], v[4:19]
    v_mfma_f32_32x32x16_bf16 v[4:19], v[32:35], v[28:31], v[4:19]
    v_mfma_f32_32x32x16_bf16 v[4:19], v[40:43], v[36:39], v[4:19]
    v_mfma_f32_32x32x16_bf16 v[4:19], v[48:51], v[44:47], v[4:19]
    s_nop 7
    s_nop 3
    s_cmp_eq_u32 s48, 0
    s_cbranch_scc0 p5_xg
    ds_write_b128 v112, v[12:15]
    ds_write_b128 v112, v[16:19] offset:1024
    v_mov_b32 v100, v4
    v_mov_b32 v101, v5
    v_mov_b32 v102, v6
    v_mov_b32 v103, v7
    v_mov_b32 v104, v8
    v_mov_b32 v105, v9
    v_mov_b32 v106, v10
    v_mov_b32 v107, v11
    s_branch p5_xg_e
p5_xg:
    ds_write_b128 v112, v[4:7]
    ds_write_b128 v112, v[8:11] offset:1024
    v_mov_b32 v100, v12
    v_mov_b32 v101, v13
    v_mov_b32 v102, v14
    v_mov_b32 v103, v15
    v_mov_b32 v104, v16
    v_mov_b32 v105, v17
    v_mov_b32 v106, v18
    v_mov_b32 v107, v19
p5_xg_e:
    v_lshlrev_b32_e64 v52, 16, v160
    v_and_b32 v53, 0xffff0000, v160
    v_lshlrev_b32_e64 v54, 16, v161
    v_and_b32 v55, 0xffff0000, v161
    v_lshlrev_b32_e64 v56, 16, v162
    v_and_b32 v57, 0xffff0000, v162
    v_lshlrev_b32_e64 v58, 16, v163
    v_and_b32 v59, 0xffff0000, v163
    v_pk_add_f32 v[100:101], v[100:101], v[52:53]
    v_pk_add_f32 v[102:103], v[102:103], v[54:55]
    v_pk_add_f32 v[104:105], v[104:105], v[56:57]
    v_pk_add_f32 v[106:107], v[106:107], v[58:59]
    s_waitcnt lgkmcnt(0)
    s_barrier
    ds_read_b128 v[20:23], v113
    ds_read_b128 v[24:27], v113 offset:1024
    s_waitcnt lgkmcnt(0)
    v_pk_add_f32 v[100:101], v[100:101], v[20:21]
    v_pk_add_f32 v[102:103], v[102:103], v[22:23]
    v_pk_add_f32 v[104:105], v[104:105], v[24:25]
    v_pk_add_f32 v[106:107], v[106:107], v[26:27]
    v_cvt_pk_bf16_f32 v108, v100, v101
    v_cvt_pk_bf16_f32 v109, v102, v103
    v_cvt_pk_bf16_f32 v110, v104, v105
    v_cvt_pk_bf16_f32 v111, v106, v107
    s_nop 1
    v_permlane32_swap_b32 v108, v110
    v_permlane32_swap_b32 v109, v111
    buffer_store_dwordx4 v[108:111], v114, s[28:31], s42 offen
sequential_preLN__sliding_block__geglu_ffn__prompt_kernel_done:
    s_endpgm
sw_p2s2:
    s_nop 3
    v_mov_b32 v100, v10
    v_mov_b32 v101, v10
    v_mov_b32 v102, v10
    v_mov_b32 v103, v10
    v_mov_b32 v104, v10
    v_mov_b32 v105, v10
    v_mov_b32 v106, v10
    v_mov_b32 v107, v10
    v_mov_b32 v108, v10
    v_mov_b32 v109, v10
    v_mov_b32 v110, v10
    v_mov_b32 v111, v10
    v_mov_b32 v112, v10
    v_mov_b32 v113, v10
    v_mov_b32 v114, v10
    v_mov_b32 v115, v10
    s_branch sw_p2s2_back
sw_p2s3:
    s_nop 3
    v_mov_b32 v100, v10
    v_mov_b32 v101, v10
    v_mov_b32 v102, v10
    v_mov_b32 v103, v10
    v_mov_b32 v104, v10
    v_mov_b32 v105, v10
    v_mov_b32 v106, v10
    v_mov_b32 v107, v10
    v_mov_b32 v108, v10
    v_mov_b32 v109, v10
    v_mov_b32 v110, v10
    v_mov_b32 v111, v10
    v_mov_b32 v112, v10
    v_mov_b32 v113, v10
    v_mov_b32 v114, v10
    v_mov_b32 v115, v10
    s_branch sw_p2s3_back
sw_p2s4:
    s_nop 3
    v_mov_b32 v100, v10
    v_mov_b32 v101, v10
    v_mov_b32 v102, v10
    v_mov_b32 v103, v10
    v_mov_b32 v104, v10
    v_mov_b32 v105, v10
    v_mov_b32 v106, v10
    v_mov_b32 v107, v10
    v_mov_b32 v108, v10
    v_mov_b32 v109, v10
    v_mov_b32 v110, v10
    v_mov_b32 v111, v10
    v_mov_b32 v112, v10
    v_mov_b32 v113, v10
    v_mov_b32 v114, v10
    v_mov_b32 v115, v10
    s_branch sw_p2s4_back
sw_p2s5:
    s_nop 3
    v_mov_b32 v100, v10
    v_mov_b32 v101, v10
    v_mov_b32 v102, v10
    v_mov_b32 v103, v10
    v_mov_b32 v104, v10
    v_mov_b32 v105, v10
    v_mov_b32 v106, v10
    v_mov_b32 v107, v10
    v_mov_b32 v108, v10
    v_mov_b32 v109, v10
    v_mov_b32 v110, v10
    v_mov_b32 v111, v10
    v_mov_b32 v112, v10
    v_mov_b32 v113, v10
    v_mov_b32 v114, v10
    v_mov_b32 v115, v10
    s_branch sw_p2s5_back
sw_p2s6:
    s_nop 3
    v_mov_b32 v100, v10
    v_mov_b32 v101, v10
    v_mov_b32 v102, v10
    v_mov_b32 v103, v10
    v_mov_b32 v104, v10
    v_mov_b32 v105, v10
    v_mov_b32 v106, v10
    v_mov_b32 v107, v10
    v_mov_b32 v108, v10
    v_mov_b32 v109, v10
    v_mov_b32 v110, v10
    v_mov_b32 v111, v10
    v_mov_b32 v112, v10
    v_mov_b32 v113, v10
    v_mov_b32 v114, v10
    v_mov_b32 v115, v10
    s_branch sw_p2s6_back
sw_p2s7:
    s_nop 3
    v_mov_b32 v100, v10
    v_mov_b32 v101, v10
    v_mov_b32 v102, v10
    v_mov_b32 v103, v10
    v_mov_b32 v104, v10
    v_mov_b32 v105, v10
    v_mov_b32 v106, v10
    v_mov_b32 v107, v10
    v_mov_b32 v108, v10
    v_mov_b32 v109, v10
    v_mov_b32 v110, v10
    v_mov_b32 v111, v10
    v_mov_b32 v112, v10
    v_mov_b32 v113, v10
    v_mov_b32 v114, v10
    v_mov_b32 v115, v10
    s_branch sw_p2s7_back
sw_p1s1:
    s_nop 3
    v_mov_b32 v100, 0
    v_mov_b32 v101, 0
    v_mov_b32 v102, 0
    v_mov_b32 v103, 0
    v_mov_b32 v104, 0
    v_mov_b32 v105, 0
    v_mov_b32 v106, 0
    v_mov_b32 v107, 0
    v_mov_b32 v108, 0
    v_mov_b32 v109, 0
    v_mov_b32 v110, 0
    v_mov_b32 v111, 0
    v_mov_b32 v112, 0
    v_mov_b32 v113, 0
    v_mov_b32 v114, 0
    v_mov_b32 v115, 0
    s_branch sw_p1s1_back
sw_p1s2:
    s_nop 3
    v_mov_b32 v100, 0
    v_mov_b32 v101, 0
    v_mov_b32 v102, 0
    v_mov_b32 v103, 0
    v_mov_b32 v104, 0
    v_mov_b32 v105, 0
    v_mov_b32 v106, 0
    v_mov_b32 v107, 0
    v_mov_b32 v108, 0
    v_mov_b32 v109, 0
    v_mov_b32 v110, 0
    v_mov_b32 v111, 0
    v_mov_b32 v112, 0
    v_mov_b32 v113, 0
    v_mov_b32 v114, 0
    v_mov_b32 v115, 0
    s_branch sw_p1s2_back
sw_p1s3:
    s_nop 3
    v_mov_b32 v100, 0
    v_mov_b32 v101, 0
    v_mov_b32 v102, 0
    v_mov_b32 v103, 0
    v_mov_b32 v104, 0
    v_mov_b32 v105, 0
    v_mov_b32 v106, 0
    v_mov_b32 v107, 0
    v_mov_b32 v108, 0
    v_mov_b32 v109, 0
    v_mov_b32 v110, 0
    v_mov_b32 v111, 0
    v_mov_b32 v112, 0
    v_mov_b32 v113, 0
    v_mov_b32 v114, 0
    v_mov_b32 v115, 0
    s_branch sw_p1s3_back
sw_p1s4:
    s_nop 3
    v_mov_b32 v100, 0
    v_mov_b32 v101, 0
    v_mov_b32 v102, 0
    v_mov_b32 v103, 0
    v_mov_b32 v104, 0
    v_mov_b32 v105, 0
    v_mov_b32 v106, 0
    v_mov_b32 v107, 0
    v_mov_b32 v108, 0
    v_mov_b32 v109, 0
    v_mov_b32 v110, 0
    v_mov_b32 v111, 0
    v_mov_b32 v112, 0
    v_mov_b32 v113, 0
    v_mov_b32 v114, 0
    v_mov_b32 v115, 0
    s_branch sw_p1s4_back
sw_p1s5:
    s_nop 3
    v_mov_b32 v100, 0
    v_mov_b32 v101, 0
    v_mov_b32 v102, 0
    v_mov_b32 v103, 0
    v_mov_b32 v104, 0
    v_mov_b32 v105, 0
    v_mov_b32 v106, 0
    v_mov_b32 v107, 0
    v_mov_b32 v108, 0
    v_mov_b32 v109, 0
    v_mov_b32 v110, 0
    v_mov_b32 v111, 0
    v_mov_b32 v112, 0
    v_mov_b32 v113, 0
    v_mov_b32 v114, 0
    v_mov_b32 v115, 0
    s_branch sw_p1s5_back
sw_p1s6:
    s_nop 3
    v_mov_b32 v100, 0
    v_mov_b32 v101, 0
    v_mov_b32 v102, 0
    v_mov_b32 v103, 0
    v_mov_b32 v104, 0
    v_mov_b32 v105, 0
    v_mov_b32 v106, 0
    v_mov_b32 v107, 0
    v_mov_b32 v108, 0
    v_mov_b32 v109, 0
    v_mov_b32 v110, 0
    v_mov_b32 v111, 0
    v_mov_b32 v112, 0
    v_mov_b32 v113, 0
    v_mov_b32 v114, 0
    v_mov_b32 v115, 0
    s_branch sw_p1s6_back
sw_p1s7:
    s_nop 3
    v_mov_b32 v100, 0
    v_mov_b32 v101, 0
    v_mov_b32 v102, 0
    v_mov_b32 v103, 0
    v_mov_b32 v104, 0
    v_mov_b32 v105, 0
    v_mov_b32 v106, 0
    v_mov_b32 v107, 0
    v_mov_b32 v108, 0
    v_mov_b32 v109, 0
    v_mov_b32 v110, 0
    v_mov_b32 v111, 0
    v_mov_b32 v112, 0
    v_mov_b32 v113, 0
    v_mov_b32 v114, 0
    v_mov_b32 v115, 0
    s_branch sw_p1s7_back
tw_2:
    buffer_store_dword v10, v11, s[36:39], s43 offen sc1
    s_branch tw_2_e
tw_5:
    buffer_store_dword v10, v11, s[36:39], s43 offen sc1
    s_branch tw_5_e
tw_7:
    buffer_store_dword v10, v11, s[36:39], s43 offen sc1
    s_branch tw_7_e
tw_9:
    buffer_store_dword v10, v11, s[36:39], s43 offen sc1
    s_branch tw_9_e
tw_10:
    buffer_store_dwordx4 v[148:151], v120, s[28:31], s42 offen sc1
    buffer_store_dwordx4 v[152:155], v120, s[28:31], s43 offen sc1
    buffer_store_dwordx4 v[156:159], v120, s[28:31], s48 offen sc1
    buffer_store_dwordx4 v[160:163], v120, s[28:31], s49 offen sc1
    s_branch tw_10_e
C_p2_exact:
    s_mov_b32 s51, 1
    v_mov_b32 v3, 0xffff
    v_mov_b32 v4, 0xffff0000
    v_cndmask_b32_e64 v44, 0, v3, s[64:65]
    v_cndmask_b32_e64 v5, 0, v4, s[66:67]
    v_or_b32 v44, v44, v5
    v_cndmask_b32_e64 v45, 0, v3, s[68:69]
    v_cndmask_b32_e64 v5, 0, v4, s[70:71]
    v_or_b32_e64 v45, v45, v5
    v_cndmask_b32_e64 v46, 0, v3, s[72:73]
    v_cndmask_b32_e64 v5, 0, v4, s[74:75]
    v_or_b32_e64 v46, v46, v5
    v_cndmask_b32_e64 v47, 0, v3, s[76:77]
    v_cndmask_b32_e64 v5, 0, v4, s[78:79]
    v_or_b32_e64 v47, v47, v5
    v_cndmask_b32_e64 v48, 0, v3, s[80:81]
    v_cndmask_b32_e64 v5, 0, v4, s[82:83]
    v_or_b32_e64 v48, v48, v5
    v_cndmask_b32_e64 v49, 0, v3, s[84:85]
    v_cndmask_b32_e64 v5, 0, v4, s[86:87]
    v_or_b32_e64 v49, v49, v5
    v_cndmask_b32_e64 v50, 0, v3, s[88:89]
    v_cndmask_b32_e64 v5, 0, v4, s[90:91]
    v_or_b32_e64 v50, v50, v5
    v_cndmask_b32_e64 v51, 0, v3, s[92:93]
    v_cndmask_b32_e64 v5, 0, v4, s[94:95]
    v_or_b32 v51, v51, v5
    s_cmp_gt_u32 s49, 0
    s_cselect_b32 s40, 0xf149f2ca, 0
    v_mov_b32 v100, s40
    v_mov_b32 v101, s40
    v_mov_b32 v102, s40
    v_mov_b32 v103, s40
    v_mov_b32 v104, s40
    v_mov_b32 v105, s40
    v_mov_b32 v106, s40
    v_mov_b32 v107, s40
    v_mov_b32 v108, s40
    v_mov_b32 v109, s40
    v_mov_b32 v110, s40
    v_mov_b32 v111, s40
    v_mov_b32 v112, s40
    v_mov_b32 v113, s40
    v_mov_b32 v114, s40
    v_mov_b32 v115, s40
    v_mov_b32 v10, 0xf149f2ca
    v_mov_b32 v6, 0xf149f2ca
    ds_read_b128 v[16:19], v7 offset:0
    ds_read_b128 v[20:23], v7 offset:8192
    s_waitcnt lgkmcnt(0)
    v_mfma_f32_32x32x16_bf16 v[52:67], v[16:19], v[12:15], v[100:115]
    v_mfma_f32_32x32x16_bf16 v[68:83], v[20:23], v[12:15], 0
    ds_read_b128 v[16:19], v7 offset:1024
    ds_read_b128 v[20:23], v7 offset:2048
    s_cmp_eq_u32 s49, 1
    s_cbranch_scc1 sw_p1s1
sw_p1s1_back:
    s_waitcnt lgkmcnt(1)
    v_mfma_f32_32x32x16_bf16 v[116:131], v[16:19], v[12:15], v[100:115]
    ds_read_b128 v[16:19], v7 offset:3072
    s_nop 4
    v_cndmask_b32_e64 v84, v52, v68, s[64:65]
    v_cndmask_b32_e64 v85, v53, v69, s[66:67]
    v_cndmask_b32_e64 v86, v54, v70, s[68:69]
    v_cndmask_b32_e64 v87, v55, v71, s[70:71]
    v_cndmask_b32_e64 v88, v56, v72, s[72:73]
    v_cndmask_b32_e64 v89, v57, v73, s[74:75]
    v_cndmask_b32_e64 v90, v58, v74, s[76:77]
    v_cndmask_b32_e64 v91, v59, v75, s[78:79]
    v_cndmask_b32_e64 v92, v60, v76, s[80:81]
    v_cndmask_b32_e64 v93, v61, v77, s[82:83]
    v_cndmask_b32_e64 v94, v62, v78, s[84:85]
    v_cndmask_b32_e64 v95, v63, v79, s[86:87]
    v_cndmask_b32_e64 v96, v64, v80, s[88:89]
    v_cndmask_b32_e64 v97, v65, v81, s[90:91]
    v_cndmask_b32_e64 v98, v66, v82, s[92:93]
    v_cndmask_b32_e64 v99, v67, v83, s[94:95]
    s_cmp_eq_u32 s49, 2
    s_cbranch_scc1 sw_p1s2
sw_p1s2_back:
    s_waitcnt lgkmcnt(1)
    v_mfma_f32_32x32x16_bf16 v[52:67], v[20:23], v[12:15], v[100:115]
    ds_read_b128 v[20:23], v7 offset:4096
    v_max3_f32 v10, v10, v84, v85
    v_max3_f32 v6, v6, v86, v87
    v_max3_f32 v10, v10, v88, v89
    v_max3_f32 v6, v6, v90, v91
    v_max3_f32 v10, v10, v92, v93
    v_max3_f32 v6, v6, v94, v95
    v_max3_f32 v10, v10, v96, v97
    v_max3_f32 v6, v6, v98, v99
    s_cmp_eq_u32 s49, 3
    s_cbranch_scc1 sw_p1s3
sw_p1s3_back:
    s_waitcnt lgkmcnt(1)
    v_mfma_f32_32x32x16_bf16 v[68:83], v[16:19], v[12:15], v[100:115]
    ds_read_b128 v[16:19], v7 offset:5120
    v_max3_f32 v10, v10, v116, v117
    v_max3_f32 v6, v6, v118, v119
    v_max3_f32 v10, v10, v120, v121
    v_max3_f32 v6, v6, v122, v123
    v_max3_f32 v10, v10, v124, v125
    v_max3_f32 v6, v6, v126, v127
    v_max3_f32 v10, v10, v128, v129
    v_max3_f32 v6, v6, v130, v131
    s_cmp_eq_u32 s49, 4
    s_cbranch_scc1 sw_p1s4
sw_p1s4_back:
    s_waitcnt lgkmcnt(1)
    v_mfma_f32_32x32x16_bf16 v[116:131], v[20:23], v[12:15], v[100:115]
    ds_read_b128 v[20:23], v7 offset:6144
    v_max3_f32 v10, v10, v52, v53
    v_max3_f32 v6, v6, v54, v55
    v_max3_f32 v10, v10, v56, v57
    v_max3_f32 v6, v6, v58, v59
    v_max3_f32 v10, v10, v60, v61
    v_max3_f32 v6, v6, v62, v63
    v_max3_f32 v10, v10, v64, v65
    v_max3_f32 v6, v6, v66, v67
    s_cmp_eq_u32 s49, 5
    s_cbranch_scc1 sw_p1s5
sw_p1s5_back:
    s_waitcnt lgkmcnt(1)
    v_mfma_f32_32x32x16_bf16 v[52:67], v[16:19], v[12:15], v[100:115]
    ds_read_b128 v[16:19], v7 offset:7168
    v_max3_f32 v10, v10, v68, v69
    v_max3_f32 v6, v6, v70, v71
    v_max3_f32 v10, v10, v72, v73
    v_max3_f32 v6, v6, v74, v75
    v_max3_f32 v10, v10, v76, v77
    v_max3_f32 v6, v6, v78, v79
    v_max3_f32 v10, v10, v80, v81
    v_max3_f32 v6, v6, v82, v83
    s_cmp_eq_u32 s49, 6
    s_cbranch_scc1 sw_p1s6
sw_p1s6_back:
    s_waitcnt lgkmcnt(1)
    v_mfma_f32_32x32x16_bf16 v[68:83], v[20:23], v[12:15], v[100:115]
    v_max3_f32 v10, v10, v116, v117
    v_max3_f32 v6, v6, v118, v119
    v_max3_f32 v10, v10, v120, v121
    v_max3_f32 v6, v6, v122, v123
    v_max3_f32 v10, v10, v124, v125
    v_max3_f32 v6, v6, v126, v127
    v_max3_f32 v10, v10, v128, v129
    v_max3_f32 v6, v6, v130, v131
    s_cmp_eq_u32 s49, 7
    s_cbranch_scc1 sw_p1s7
sw_p1s7_back:
    s_waitcnt lgkmcnt(0)
    v_mfma_f32_32x32x16_bf16 v[116:131], v[16:19], v[12:15], v[100:115]
    v_max3_f32 v10, v10, v52, v53
    v_max3_f32 v6, v6, v54, v55
    v_max3_f32 v10, v10, v56, v57
    v_max3_f32 v6, v6, v58, v59
    v_max3_f32 v10, v10, v60, v61
    v_max3_f32 v6, v6, v62, v63
    v_max3_f32 v10, v10, v64, v65
    v_max3_f32 v6, v6, v66, v67
    ds_read_b128 v[16:19], v7 offset:1024
    ds_read_b128 v[20:23], v7 offset:2048
    v_max3_f32 v10, v10, v68, v69
    v_max3_f32 v6, v6, v70, v71
    v_max3_f32 v10, v10, v72, v73
    v_max3_f32 v6, v6, v74, v75
    v_max3_f32 v10, v10, v76, v77
    v_max3_f32 v6, v6, v78, v79
    v_max3_f32 v10, v10, v80, v81
    v_max3_f32 v6, v6, v82, v83
    v_max3_f32 v10, v10, v116, v117
    v_max3_f32 v6, v6, v118, v119
    v_max3_f32 v10, v10, v120, v121
    v_max3_f32 v6, v6, v122, v123
    v_max3_f32 v10, v10, v124, v125
    v_max3_f32 v6, v6, v126, v127
    v_max3_f32 v10, v10, v128, v129
    v_max3_f32 v6, v6, v130, v131
    v_max_f32 v10, v10, v6
    v_mov_b32 v1, v10
    s_nop 1
    v_permlane32_swap_b32 v10, v1
    v_max_f32 v10, v10, v1
    v_sub_f32_e64 v10, 0, v10
    s_cmp_gt_u32 s49, 1
    s_cselect_b64 s[40:41], -1, 0
    v_mov_b32 v2, 0xf149f2ca
    v_cndmask_b32_e64 v3, v10, v2, s[40:41]
    v_mov_b32 v100, v3
    v_mov_b32 v101, v3
    v_mov_b32 v102, v3
    v_mov_b32 v103, v3
    v_mov_b32 v104, v3
    v_mov_b32 v105, v3
    v_mov_b32 v106, v3
    v_mov_b32 v107, v3
    v_mov_b32 v108, v3
    v_mov_b32 v109, v3
    v_mov_b32 v110, v3
    v_mov_b32 v111, v3
    v_mov_b32 v112, v3
    v_mov_b32 v113, v3
    v_mov_b32 v114, v3
    v_mov_b32 v115, v3
    s_branch C_p2_entry
tw_11:
    buffer_store_dwordx2 v[52:53], v91, s[32:35], s43 offen sc1
    s_branch tw_11_e
tw_12:
    buffer_store_dwordx4 v[20:23], v115, s[28:31], s42 offen sc1
    s_branch tw_12_e
tw_13:
    buffer_store_dwordx4 v[104:107], v103, s[28:31], s48 offen sc1
    buffer_store_dwordx4 v[108:111], v103, s[28:31], s49 offen sc1
    buffer_store_dwordx4 v[112:115], v103, s[28:31], s50 offen sc1
    s_branch tw_13_e
sequential_preLN__sliding_block__geglu_ffn__prompt_kernel_end:
    s_endpgm
.section .rodata,"a"
.p2align 6
.amdhsa_kernel sequential_preLN__sliding_block__geglu_ffn__prompt_kernel
  .amdhsa_next_free_vgpr 168
  .amdhsa_next_free_sgpr 102
  .amdhsa_accum_offset 168
  .amdhsa_group_segment_fixed_size 0
  .amdhsa_kernarg_size 80
  .amdhsa_user_sgpr_count 2
  .amdhsa_user_sgpr_kernarg_segment_ptr 1
  .amdhsa_system_sgpr_workgroup_id_x 1
  .amdhsa_float_denorm_mode_32 3
.end_amdhsa_kernel
```
